```python
import torch

def _softmax(x, axis=-1):
    return torch.softmax(x, dim=axis)
def _gelu(x):
    return torch.nn.functional.gelu(x, approximate="tanh")
def _silu(x):
    return torch.nn.functional.silu(x)
def _sigmoid(x):
    return torch.sigmoid(x)
def _layernorm(x, axis=-1, eps=1e-5):
    m = x.mean(dim=axis, keepdim=True)
    v = x.var(dim=axis, keepdim=True, unbiased=False)
    return (x - m) / torch.sqrt(v + eps)
def _scatter_add(tgt, idx, src, axis=0):
    return tgt.clone().index_add_(axis, idx, src)
def _segment_sum(src, seg, n):
    out = torch.zeros((n,) + src.shape[1:], dtype=src.dtype)
    return out.index_add_(0, seg, src)
def _pad(x, pw):
    flat = tuple(v for pair in reversed(pw) for v in pair)
    return torch.nn.functional.pad(x, flat)

kernel_name = 'parallel_sum__sliding_local_dilated__geglu_ffn__prompt'

def setup_inputs():

    _w = (lambda a: (lambda t: t.to(torch.bfloat16) if t.is_floating_point() else t)(torch.as_tensor(a)))
    def _A_setup():
        B, S, D = 1, 2048, 640
        return {
            "x": _w((lambda *s: torch.randn(*s, dtype=torch.bfloat16) * 0.05)(B, S, D)),
            "wqkv": _w((lambda *s: torch.randn(*s, dtype=torch.bfloat16) * 0.05)(D, 3 * D)),
            "wo": _w((lambda *s: torch.randn(*s, dtype=torch.bfloat16) * 0.05)(D, D)),
        }
    _A_in = _A_setup()

    def _B_setup():
        B, S, D, F = 1, 2048, 640, 1728
        return {
            "x": _w((lambda *s: torch.randn(*s, dtype=torch.bfloat16) * 0.05)(B, S, D)),
            "w_gate": _w((lambda *s: torch.randn(*s, dtype=torch.bfloat16) * 0.05)(D, F)),
            "w_up": _w((lambda *s: torch.randn(*s, dtype=torch.bfloat16) * 0.05)(D, F)),
            "w_down": _w((lambda *s: torch.randn(*s, dtype=torch.bfloat16) * 0.05)(F, D)),
        }
    _B_in = _B_setup()

    return {
        "A_x": _A_in["x"],
        "A_wqkv": _A_in["wqkv"],
        "A_wo": _A_in["wo"],
        "B_x": _B_in["x"],
        "B_w_gate": _B_in["w_gate"],
        "B_w_up": _B_in["w_up"],
        "B_w_down": _B_in["w_down"],
    }

def reference(A_x, A_wqkv, A_wo, B_x, B_w_gate, B_w_up, B_w_down):
    def _A_ref(x, wqkv, wo):
        B, S, D = x.shape
        H = 32; Dh = D // H
        W, dil = 8, 2
        qkv = (lambda x, *d: x.permute(*d))((x @ wqkv).reshape(B, S, 3, H, Dh), 2, 0, 3, 1, 4)
        q, k, v = qkv[0], qkv[1], qkv[2]
        scale = Dh ** -0.5
        pos = torch.arange(S)
        off = torch.arange(W) * dil
        idx = pos[:, None] - off[None, :]
        mask = idx >= 0
        idx_c = torch.where(mask, idx, 0).reshape(-1)
        kg = k[:, :, idx_c, :].reshape(B, H, S, W, Dh)
        vg = v[:, :, idx_c, :].reshape(B, H, S, W, Dh)
        logits = torch.einsum("bhsd,bhswd->bhsw", q, kg) * scale
        logits = torch.where(mask[None, None, :, :], logits, -1e9)
        attn = _softmax(logits, axis=-1)
        o = torch.einsum("bhsw,bhswd->bhsd", attn, vg)
        return (lambda x, *d: x.permute(*d))(o, 0, 2, 1, 3).reshape(B, S, D) @ wo

    def _B_ref(x, w_gate, w_up, w_down):
        return (_gelu(x @ w_gate) * (x @ w_up)) @ w_down

    x = A_x
    xn = _layernorm(x, axis=-1)
    return x + _A_ref(xn, A_wqkv, A_wo) + _B_ref(xn, B_w_gate, B_w_up, B_w_down)
```

```asm
; @launch kernel=k1_kernel grid=(256,1,1) block=(512,1,1) lds=163840
; @launch kernel=k2_kernel grid=(256,1,1) block=(256,1,1) lds=81920
.amdgcn_target "amdgcn-amd-amdhsa--gfx950"
.text
    .p2align 8
    .globl k1_kernel
    .type k1_kernel,@function
k1_kernel:
    s_cmp_ge_u32 s2, 256
    s_cbranch_scc1 K1_end
    s_load_dwordx2 s[4:5], s[0:1], 0
    s_load_dwordx2 s[6:7], s[0:1], 8
    s_load_dwordx2 s[28:29], s[0:1], 32
    s_load_dwordx2 s[30:31], s[0:1], 40
    s_load_dwordx2 s[32:33], s[0:1], 72
    s_load_dwordx2 s[24:25], s[0:1], 64
    v_lshrrev_b32 v1, 6, v0
    v_and_b32 v0, 63, v0
    s_and_b32 s34, s2, 7
    v_readfirstlane_b32 s38, v1
    s_lshr_b32 s35, s2, 3
    s_lshr_b32 s52, s34, 2
    s_and_b32 s53, s34, 3
    s_and_b32 s39, s38, 3
    s_lshr_b32 s40, s38, 2
    s_mov_b32 s54, 0x40000000
    s_and_b32 s51, s53, 1
    s_lshl_b32 s51, s51, 2
    s_sub_u32 s59, 20, s51
    s_add_u32 s61, s59, 12
    s_mul_i32 s60, s35, 3
    s_mul_i32 s51, s60, 3277
    s_lshr_b32 s51, s51, 16
    s_mul_i32 s51, s51, 20
    s_sub_u32 s60, s60, s51
    s_mov_b32 s60, 0
    v_lshrrev_b32 v14, 2, v0
    v_lshrrev_b32 v17, 4, v0
    v_and_b32 v18, 15, v0
    v_sub_u32 v15, 4, v17
    v_and_b32 v15, 3, v15
    v_and_b32 v19, 3, v0
    v_xor_b32 v15, v15, v19
    v_lshlrev_b32 v15, 4, v15
    v_lshrrev_b32 v16, 5, v0
    v_lshlrev_b32 v16, 1, v16
    v_xor_b32 v16, v16, v19
    s_waitcnt lgkmcnt(0)
    s_mov_b32 s8, s4
    s_and_b32 s9, s5, 0xffff
    s_mov_b32 s10, 2621440
    s_mov_b32 s11, 0x00020000
    s_mov_b32 s20, s32
    s_and_b32 s21, s33, 0xffff
    s_mov_b32 s22, 9699328
    s_mov_b32 s23, 0x00020000
    s_and_b32 s25, s25, 0xffff
    s_mov_b32 s26, 256
    s_mov_b32 s27, 0x00020000
    s_lshl_b32 s62, s52, 10
    s_sub_u32 s62, s62, 14
    s_max_i32 s62, s62, 0
    s_mul_i32 s62, s62, 1280
    s_mul_i32 s63, s53, 9
    s_add_u32 s63, s63, 1
    s_lshr_b32 s63, s63, 1
    s_mul_i32 s63, s63, 192
    s_andn2_b32 s63, s63, 127
    s_mul_i32 s56, s53, 320
    s_andn2_b32 s56, s56, 127
    s_mul_i32 s51, s38, 16
    s_add_u32 s51, s51, s35
    s_cmp_ge_u32 s35, 16
    s_cselect_b32 s51, 100, s51
    s_mov_b32 s80, s4
    s_mov_b32 s81, s5
    s_mov_b32 s82, 2621440
    s_mov_b32 s16, 65536
    s_mov_b32 s17, 1
    s_mov_b32 s18, 1280
    s_mov_b32 s84, s62
    s_mov_b32 s85, 128
    s_mov_b32 s55, 0
    s_cmp_ge_u32 s51, 17
    s_cselect_b32 s80, s28, s80
    s_cselect_b32 s81, s29, s81
    s_cselect_b32 s82, 2211840, s82
    s_cselect_b32 s16, 7282, s16
    s_cselect_b32 s17, 9, s17
    s_cselect_b32 s18, 3456, s18
    s_cselect_b32 s84, s63, s84
    s_cselect_b32 s85, 221184, s85
    s_cselect_b32 s55, 17, s55
    s_cmp_ge_u32 s51, 26
    s_cselect_b32 s80, s30, s80
    s_cselect_b32 s81, s31, s81
    s_cselect_b32 s55, 26, s55
    s_cmp_ge_u32 s51, 35
    s_cselect_b32 s80, s6, s80
    s_cselect_b32 s81, s7, s81
    s_cselect_b32 s82, 2457600, s82
    s_cselect_b32 s16, 16384, s16
    s_cselect_b32 s17, 4, s17
    s_cselect_b32 s18, 1280, s18
    s_cselect_b32 s84, s56, s84
    s_cselect_b32 s85, 245760, s85
    s_cselect_b32 s55, 35, s55
    s_and_b32 s81, s81, 0xffff
    s_mov_b32 s83, 0x00020000
    s_cmp_ge_u32 s51, 47
    s_cselect_b32 s57, s54, 0
    s_cselect_b32 s85, 0, s85
    s_sub_u32 s51, s51, s55
    s_lshl_b32 s51, s51, 6
    v_add_u32 v19, s51, v0
    v_mul_u32_u24 v20, s16, v19
    v_lshrrev_b32 v20, 16, v20
    v_mul_u32_u24 v21, s17, v20
    v_sub_u32 v21, v19, v21
    v_mul_u32_u24 v20, s18, v20
    v_lshl_add_u32 v20, v21, 7, v20
    v_or_b32 v139, s57, v20
    s_mov_b32 s88, s84
    s_lshr_b32 s87, s60, 1
    s_mul_i32 s51, s87, s85
    s_add_u32 s84, s84, s51
    buffer_load_dword v138, v139, s[80:83], s84 offen
    s_add_u32 s84, s84, s85
    s_add_u32 s87, s87, 1
    s_cmp_eq_u32 s87, 10
    s_cselect_b32 s84, s88, s84
    s_cselect_b32 s87, 0, s87
    buffer_load_dword v137, v139, s[80:83], s84 offen
    s_add_u32 s84, s84, s85
    s_add_u32 s87, s87, 1
    s_cmp_eq_u32 s87, 10
    s_cselect_b32 s84, s88, s84
    s_cselect_b32 s87, 0, s87
    s_cmp_ge_u32 s35, s61
    s_cbranch_scc1 K1_helper
    s_cmp_ge_u32 s35, s59
    s_cbranch_scc1 K1_qkv
    s_and_b32 s36, s35, 3
    s_lshl_b32 s51, s52, 2
    s_add_u32 s36, s36, s51
    s_lshr_b32 s37, s35, 2
    s_mul_i32 s51, s53, 9
    s_add_u32 s51, s51, 1
    s_lshr_b32 s51, s51, 1
    s_add_u32 s37, s37, s51
    s_cmp_lt_u32 s38, 6
    s_cselect_b32 s12, s28, s30
    s_cselect_b32 s13, s29, s31
    s_and_b32 s13, s13, 0xffff
    s_mov_b32 s14, 2211840
    s_mov_b32 s15, 0x00020000
    s_mov_b32 s16, s30
    s_and_b32 s17, s31, 0xffff
    s_mov_b32 s18, 2211840
    s_mov_b32 s19, 0x00020000
    s_mov_b32 s50, 110592
    s_lshl_b32 s51, s36, 8
    s_lshl_b32 s55, s38, 4
    s_add_u32 s51, s51, s55
    v_add_u32 v19, s51, v14
    v_mul_i32_i24 v20, 1280, v19
    v_add_u32 v20, v20, v15
    v_cmp_gt_i32 vcc, 0, v19
    v_mov_b32 v21, s54
    s_nop 0
    v_cndmask_b32 v1, v20, v21, vcc
    s_add_u32 s51, s51, 128
    v_add_u32 v19, s51, v14
    v_mul_i32_i24 v20, 1280, v19
    v_add_u32 v20, v20, v15
    v_cmp_gt_i32 vcc, 0, v19
    v_mov_b32 v21, s54
    s_nop 0
    v_cndmask_b32 v2, v20, v21, vcc
    s_lshl_b32 s46, s38, 10
    s_add_u32 s47, s46, 8192
    s_add_u32 s51, s38, 0
    s_cmp_ge_u32 s51, 6
    s_cselect_b32 s55, 6, 0
    s_sub_u32 s55, s51, s55
    s_lshr_b32 s55, s55, 1
    s_lshl_b32 s55, s55, 6
    s_mul_i32 s56, s37, 192
    s_add_u32 s55, s55, s56
    s_and_b32 s56, s51, 1
    s_lshl_b32 s56, s56, 4
    v_add_u32 v19, s56, v14
    v_mul_u32_u24 v19, 3456, v19
    v_lshlrev_b32 v20, 4, v16
    v_add3_u32 v3, v19, v20, s55
    s_lshl_b32 s48, s51, 10
    s_add_u32 s48, s48, 16384
    s_add_u32 s51, s38, 8
    s_cmp_ge_u32 s51, 6
    s_cselect_b32 s55, 6, 0
    s_sub_u32 s55, s51, s55
    s_lshr_b32 s55, s55, 1
    s_lshl_b32 s55, s55, 6
    s_mul_i32 s56, s37, 192
    s_add_u32 s55, s55, s56
    s_and_b32 s56, s51, 1
    s_lshl_b32 s56, s56, 4
    v_add_u32 v19, s56, v14
    v_mul_u32_u24 v19, 3456, v19
    v_lshlrev_b32 v20, 4, v16
    v_add3_u32 v4, v19, v20, s55
    s_lshl_b32 s49, s51, 10
    s_add_u32 s49, s49, 16384
    s_cmp_ge_u32 s38, 4
    s_cselect_b32 s49, 28672, s49
    s_cselect_b32 s55, s54, 0
    v_or_b32 v4, s55, v4
    s_mul_i32 s51, s39, 4096
    v_lshlrev_b32 v19, 6, v18
    v_lshrrev_b32 v20, 2, v18
    v_sub_u32 v21, 4, v20
    v_and_b32 v21, 3, v21
    v_xor_b32 v21, v21, v17
    v_lshlrev_b32 v21, 4, v21
    v_add3_u32 v5, v19, v21, s51
    v_lshl_add_u32 v19, v17, 3, v20
    v_lshlrev_b32 v19, 6, v19
    v_and_b32 v21, 3, v18
    v_lshlrev_b32 v21, 3, v21
    v_add_u32 v22, v19, v21
    v_add_u32 v22, 16384, v22
    v_and_b32 v23, 1, v17
    v_lshlrev_b32 v23, 5, v23
    v_xor_b32 v21, 32, v23
    v_add_u32 v19, v22, v23
    v_add_u32 v20, v22, v21
    s_cmp_eq_u32 s40, 0
    s_cselect_b32 s51, 0, 4096
    s_cselect_b32 s55, 2048, 2048
    v_add_u32 v6, s51, v19
    v_add_u32 v7, s51, v20
    s_cselect_b64 vcc, -1, 0
    v_add_u32 v19, s55, v19
    v_add_u32 v20, s55, v20
    s_nop 0
    v_cndmask_b32 v8, v20, v19, vcc
    s_lshl_b32 s51, s40, 11
    v_add_u32 v252, s51, v5
    v_mov_b32 v253, v6
    v_mov_b32 v254, v7
    s_cmp_eq_u32 s39, 1
    s_cbranch_scc0 F_sb1
    v_mov_b32 v253, v8
    v_add_u32 v254, 6144, v6
F_sb1:
    s_cmp_eq_u32 s39, 2
    s_cbranch_scc0 F_sb2
    v_add_u32 v253, 6144, v7
    v_add_u32 v254, 6144, v8
F_sb2:
    s_lshl_b32 s58, s36, 8
    s_mov_b32 s41, 0
    s_mov_b32 s61, 0
    s_lshl_b32 s43, s60, 6
    s_mul_i32 s44, s60, s50
    v_mov_b32 v16, v139
    s_add_u32 m0, s41, s46
    s_nop 0
    buffer_load_dwordx4 v1, s[8:11], s43 offen lds
    s_add_u32 m0, s41, s47
    s_nop 0
    buffer_load_dwordx4 v2, s[8:11], s43 offen lds
    s_add_u32 m0, s41, s48
    s_nop 0
    buffer_load_dwordx4 v3, s[12:15], s44 offen lds
    s_add_u32 m0, s41, s49
    s_nop 0
    buffer_load_dwordx4 v4, s[16:19], s44 offen lds
    s_add_u32 s41, s41, 29696
    s_cmp_eq_u32 s41, 148480
    s_cselect_b32 s41, 0, s41
    s_add_u32 s43, s43, 64
    s_add_u32 s44, s44, s50
    s_cmp_eq_u32 s43, 1280
    s_cselect_b32 s43, 0, s43
    s_cselect_b32 s44, 0, s44
    s_add_u32 s61, s61, 1
    s_cmp_ge_u32 s61, 20
    s_cselect_b32 s43, s54, s43
    s_cselect_b32 s44, s54, s44
    s_add_u32 m0, s41, s46
    s_nop 0
    buffer_load_dwordx4 v1, s[8:11], s43 offen lds
    s_add_u32 m0, s41, s47
    s_nop 0
    buffer_load_dwordx4 v2, s[8:11], s43 offen lds
    s_add_u32 m0, s41, s48
    s_nop 0
    buffer_load_dwordx4 v3, s[12:15], s44 offen lds
    s_add_u32 m0, s41, s49
    s_nop 0
    buffer_load_dwordx4 v4, s[16:19], s44 offen lds
    s_add_u32 s41, s41, 29696
    s_cmp_eq_u32 s41, 148480
    s_cselect_b32 s41, 0, s41
    s_add_u32 s43, s43, 64
    s_add_u32 s44, s44, s50
    s_cmp_eq_u32 s43, 1280
    s_cselect_b32 s43, 0, s43
    s_cselect_b32 s44, 0, s44
    s_add_u32 s61, s61, 1
    s_cmp_ge_u32 s61, 20
    s_cselect_b32 s43, s54, s43
    s_cselect_b32 s44, s54, s44
    s_add_u32 m0, s41, s46
    s_nop 0
    buffer_load_dwordx4 v1, s[8:11], s43 offen lds
    s_add_u32 m0, s41, s47
    s_nop 0
    buffer_load_dwordx4 v2, s[8:11], s43 offen lds
    s_add_u32 m0, s41, s48
    s_nop 0
    buffer_load_dwordx4 v3, s[12:15], s44 offen lds
    s_add_u32 m0, s41, s49
    s_nop 0
    buffer_load_dwordx4 v4, s[16:19], s44 offen lds
    s_add_u32 s41, s41, 29696
    s_cmp_eq_u32 s41, 148480
    s_cselect_b32 s41, 0, s41
    s_add_u32 s43, s43, 64
    s_add_u32 s44, s44, s50
    s_cmp_eq_u32 s43, 1280
    s_cselect_b32 s43, 0, s43
    s_cselect_b32 s44, 0, s44
    s_add_u32 s61, s61, 1
    s_cmp_ge_u32 s61, 20
    s_cselect_b32 s43, s54, s43
    s_cselect_b32 s44, s54, s44
    s_add_u32 s28, s32, 12730368
    s_addc_u32 s29, s33, 0
    s_and_b32 s29, s29, 0xffff
    s_mov_b32 s30, 65536
    s_mov_b32 s31, 0x00020000
    s_mul_i32 s51, s39, 64
    s_add_u32 s51, s51, s58
    v_add_u32 v23, s51, v18
    v_mov_b32 v22, s54
    v_mov_b32 v17, 0
    v_lshlrev_b32 v18, 5, v23
    v_add_u32 v18, 0, v18
    v_cmp_gt_i32 vcc, 0, v23
    v_add_u32 v23, 16, v23
    s_nop 0
    v_cndmask_b32 v18, v18, v22, vcc
    v_lshlrev_b32 v19, 5, v23
    v_add_u32 v19, 0, v19
    v_cmp_gt_i32 vcc, 0, v23
    v_add_u32 v23, 16, v23
    s_nop 0
    v_cndmask_b32 v19, v19, v22, vcc
    v_lshlrev_b32 v20, 5, v23
    v_add_u32 v20, 0, v20
    v_cmp_gt_i32 vcc, 0, v23
    v_add_u32 v23, 16, v23
    s_nop 0
    v_cndmask_b32 v20, v20, v22, vcc
    v_lshlrev_b32 v21, 5, v23
    v_add_u32 v21, 0, v21
    v_cmp_gt_i32 vcc, 0, v23
    v_add_u32 v23, 16, v23
    s_nop 0
    v_cndmask_b32 v21, v21, v22, vcc
    v_mov_b32 v24, 0x3f803f80
    v_mov_b32 v25, 0x3f803f80
    v_mov_b32 v26, 0x3f803f80
    v_mov_b32 v27, 0x3f803f80
    v_mov_b32 v28, 0
    v_mov_b32 v29, 0
    v_mov_b32 v30, 0
    v_mov_b32 v31, 0
    v_mov_b32 v32, 0
    v_mov_b32 v33, 0
    v_mov_b32 v34, 0
    v_mov_b32 v35, 0
    v_mov_b32 v36, 0
    v_mov_b32 v37, 0
    v_mov_b32 v38, 0
    v_mov_b32 v39, 0
    v_mov_b32 v40, 0
    v_mov_b32 v41, 0
    v_mov_b32 v42, 0
    v_mov_b32 v43, 0
    v_mov_b32 v44, 0
    v_mov_b32 v45, 0
    v_mov_b32 v46, 0
    v_mov_b32 v47, 0
    v_mov_b32 v48, 0
    v_mov_b32 v49, 0
    v_mov_b32 v50, 0
    v_mov_b32 v51, 0
    v_mov_b32 v140, 0
    v_mov_b32 v141, 0
    v_mov_b32 v142, 0
    v_mov_b32 v143, 0
    v_mov_b32 v144, 0
    v_mov_b32 v145, 0
    v_mov_b32 v146, 0
    v_mov_b32 v147, 0
    v_mov_b32 v148, 0
    v_mov_b32 v149, 0
    v_mov_b32 v150, 0
    v_mov_b32 v151, 0
    v_mov_b32 v152, 0
    v_mov_b32 v153, 0
    v_mov_b32 v154, 0
    v_mov_b32 v155, 0
    v_mov_b32 v156, 0
    v_mov_b32 v157, 0
    v_mov_b32 v158, 0
    v_mov_b32 v159, 0
    v_mov_b32 v160, 0
    v_mov_b32 v161, 0
    v_mov_b32 v162, 0
    v_mov_b32 v163, 0
    v_mov_b32 v164, 0
    v_mov_b32 v165, 0
    v_mov_b32 v166, 0
    v_mov_b32 v167, 0
    v_mov_b32 v168, 0
    v_mov_b32 v169, 0
    v_mov_b32 v170, 0
    v_mov_b32 v171, 0
    v_mov_b32 v172, 0
    v_mov_b32 v173, 0
    v_mov_b32 v174, 0
    v_mov_b32 v175, 0
    v_mov_b32 v176, 0
    v_mov_b32 v177, 0
    v_mov_b32 v178, 0
    v_mov_b32 v179, 0
    v_mov_b32 v180, 0
    v_mov_b32 v181, 0
    v_mov_b32 v182, 0
    v_mov_b32 v183, 0
    v_mov_b32 v184, 0
    v_mov_b32 v185, 0
    v_mov_b32 v186, 0
    v_mov_b32 v187, 0
    v_mov_b32 v188, 0
    v_mov_b32 v189, 0
    v_mov_b32 v190, 0
    v_mov_b32 v191, 0
    v_mov_b32 v192, 0
    v_mov_b32 v193, 0
    v_mov_b32 v194, 0
    v_mov_b32 v195, 0
    v_mov_b32 v196, 0
    v_mov_b32 v197, 0
    v_mov_b32 v198, 0
    v_mov_b32 v199, 0
    v_mov_b32 v200, 0
    v_mov_b32 v201, 0
    v_mov_b32 v202, 0
    v_mov_b32 v203, 0
    v_mov_b32 v204, 0
    v_mov_b32 v205, 0
    v_mov_b32 v206, 0
    v_mov_b32 v207, 0
    v_mov_b32 v208, 0
    v_mov_b32 v209, 0
    v_mov_b32 v210, 0
    v_mov_b32 v211, 0
    v_mov_b32 v212, 0
    v_mov_b32 v213, 0
    v_mov_b32 v214, 0
    v_mov_b32 v215, 0
    v_mov_b32 v216, 0
    v_mov_b32 v217, 0
    v_mov_b32 v218, 0
    v_mov_b32 v219, 0
    v_mov_b32 v220, 0
    v_mov_b32 v221, 0
    v_mov_b32 v222, 0
    v_mov_b32 v223, 0
    v_mov_b32 v224, 0
    v_mov_b32 v225, 0
    v_mov_b32 v226, 0
    v_mov_b32 v227, 0
    v_mov_b32 v228, 0
    v_mov_b32 v229, 0
    v_mov_b32 v230, 0
    v_mov_b32 v231, 0
    v_mov_b32 v232, 0
    v_mov_b32 v233, 0
    v_mov_b32 v234, 0
    v_mov_b32 v235, 0
    s_mov_b32 s42, 0
    s_mov_b32 s45, 0
    s_waitcnt vmcnt(8)
    s_barrier
    v_add_u32 v9, s42, v5
    v_add_u32 v10, s42, v6
    v_add_u32 v11, s42, v7
    v_add_u32 v12, s42, v8
    v_add_u32 v255, s42, v253
    v_add_u32 v14, s42, v254
    ds_read_b64_tr_b16 v[244:245], v255 offset:0
    ds_read_b64_tr_b16 v[246:247], v255 offset:256
    ds_read_b64_tr_b16 v[248:249], v14 offset:0
    ds_read_b64_tr_b16 v[250:251], v14 offset:256
    ds_read_b128 v[52:55], v9 offset:0
    ds_read_b128 v[56:59], v9 offset:1024
    ds_read_b128 v[60:63], v9 offset:2048
    ds_read_b128 v[64:67], v9 offset:3072
    ds_read_b64_tr_b16 v[68:69], v10 offset:0
    ds_read_b64_tr_b16 v[70:71], v10 offset:256
    ds_read_b64_tr_b16 v[72:73], v11 offset:0
    ds_read_b64_tr_b16 v[74:75], v11 offset:256
    ds_read_b64_tr_b16 v[76:77], v12 offset:0
    ds_read_b64_tr_b16 v[78:79], v12 offset:256
    ds_read_b64_tr_b16 v[80:81], v10 offset:6144
    ds_read_b64_tr_b16 v[82:83], v10 offset:6400
    ds_read_b64_tr_b16 v[84:85], v11 offset:6144
    ds_read_b64_tr_b16 v[86:87], v11 offset:6400
    ds_read_b64_tr_b16 v[88:89], v12 offset:6144
    ds_read_b64_tr_b16 v[90:91], v12 offset:6400
    s_mov_b32 s42, 29696
    v_add_u32 v9, s42, v5
    v_add_u32 v10, s42, v6
    v_add_u32 v11, s42, v7
    v_add_u32 v12, s42, v8
    v_add_u32 v255, s42, v253
    v_add_u32 v14, s42, v254
    s_waitcnt lgkmcnt(15)
    v_mfma_f32_16x16x32_bf16 v[44:47], v[244:247], v[24:27], v[44:47]
    v_mfma_f32_16x16x32_bf16 v[48:51], v[248:251], v[24:27], v[48:51]
    s_add_u32 s42, s42, 29696
    s_waitcnt vmcnt(4) lgkmcnt(0)
    s_barrier
    v_mfma_f32_16x16x32_bf16 v[140:143], v[68:71], v[52:55], v[140:143]
    buffer_load_dword v15, v16, s[80:83], s84 offen
    s_add_u32 s84, s84, s85
    s_add_u32 s87, s87, 1
    s_cmp_eq_u32 s87, 10
    s_cselect_b32 s84, s88, s84
    s_cselect_b32 s87, 0, s87
    buffer_load_dword v15, v16, s[80:83], s84 offen
    s_add_u32 s84, s84, s85
    s_add_u32 s87, s87, 1
    s_cmp_eq_u32 s87, 10
    s_cselect_b32 s84, s88, s84
    s_cselect_b32 s87, 0, s87
    ds_read_b64_tr_b16 v[244:245], v255 offset:0
    s_add_u32 m0, s41, s46
    v_mfma_f32_16x16x32_bf16 v[144:147], v[68:71], v[56:59], v[144:147]
    buffer_load_dwordx4 v1, s[8:11], s43 offen lds
    ds_read_b64_tr_b16 v[246:247], v255 offset:256
    v_mfma_f32_16x16x32_bf16 v[148:151], v[68:71], v[60:63], v[148:151]
    ds_read_b64_tr_b16 v[248:249], v14 offset:0
    s_add_u32 m0, s41, s47
    v_mfma_f32_16x16x32_bf16 v[152:155], v[68:71], v[64:67], v[152:155]
    buffer_load_dwordx4 v2, s[8:11], s43 offen lds
    ds_read_b64_tr_b16 v[250:251], v14 offset:256
    v_mfma_f32_16x16x32_bf16 v[156:159], v[72:75], v[52:55], v[156:159]
    ds_read_b128 v[92:95], v9 offset:0
    s_add_u32 m0, s41, s48
    v_mfma_f32_16x16x32_bf16 v[160:163], v[72:75], v[56:59], v[160:163]
    buffer_load_dwordx4 v3, s[12:15], s44 offen lds
    ds_read_b128 v[96:99], v9 offset:1024
    v_mfma_f32_16x16x32_bf16 v[164:167], v[72:75], v[60:63], v[164:167]
    ds_read_b128 v[100:103], v9 offset:2048
    s_add_u32 m0, s41, s49
    v_mfma_f32_16x16x32_bf16 v[168:171], v[72:75], v[64:67], v[168:171]
    buffer_load_dwordx4 v4, s[16:19], s44 offen lds
    ds_read_b128 v[104:107], v9 offset:3072
    v_mfma_f32_16x16x32_bf16 v[172:175], v[76:79], v[52:55], v[172:175]
    ds_read_b64_tr_b16 v[108:109], v10 offset:0
    s_add_u32 s41, s41, 29696
    s_cmp_eq_u32 s41, 148480
    s_cselect_b32 s41, 0, s41
    v_mfma_f32_16x16x32_bf16 v[176:179], v[76:79], v[56:59], v[176:179]
    ds_read_b64_tr_b16 v[110:111], v10 offset:256
    s_add_u32 s43, s43, 64
    s_add_u32 s44, s44, s50
    s_cmp_eq_u32 s43, 1280
    s_cselect_b32 s43, 0, s43
    s_cselect_b32 s44, 0, s44
    v_mfma_f32_16x16x32_bf16 v[180:183], v[76:79], v[60:63], v[180:183]
    s_add_u32 s61, s61, 1
    s_cmp_ge_u32 s61, 20
    s_cselect_b32 s43, s54, s43
    s_cselect_b32 s44, s54, s44
    v_mfma_f32_16x16x32_bf16 v[184:187], v[76:79], v[64:67], v[184:187]
    ds_read_b64_tr_b16 v[112:113], v11 offset:0
    s_add_u32 m0, s41, s46
    v_mfma_f32_16x16x32_bf16 v[188:191], v[80:83], v[52:55], v[188:191]
    buffer_load_dwordx4 v1, s[8:11], s43 offen lds
    ds_read_b64_tr_b16 v[114:115], v11 offset:256
    v_mfma_f32_16x16x32_bf16 v[192:195], v[80:83], v[56:59], v[192:195]
    ds_read_b64_tr_b16 v[116:117], v12 offset:0
    s_add_u32 m0, s41, s47
    v_mfma_f32_16x16x32_bf16 v[196:199], v[80:83], v[60:63], v[196:199]
    buffer_load_dwordx4 v2, s[8:11], s43 offen lds
    ds_read_b64_tr_b16 v[118:119], v12 offset:256
    v_mfma_f32_16x16x32_bf16 v[200:203], v[80:83], v[64:67], v[200:203]
    ds_read_b64_tr_b16 v[120:121], v10 offset:6144
    s_add_u32 m0, s41, s48
    v_mfma_f32_16x16x32_bf16 v[204:207], v[84:87], v[52:55], v[204:207]
    buffer_load_dwordx4 v3, s[12:15], s44 offen lds
    ds_read_b64_tr_b16 v[122:123], v10 offset:6400
    v_mfma_f32_16x16x32_bf16 v[208:211], v[84:87], v[56:59], v[208:211]
    ds_read_b64_tr_b16 v[124:125], v11 offset:6144
    s_add_u32 m0, s41, s49
    v_mfma_f32_16x16x32_bf16 v[212:215], v[84:87], v[60:63], v[212:215]
    buffer_load_dwordx4 v4, s[16:19], s44 offen lds
    ds_read_b64_tr_b16 v[126:127], v11 offset:6400
    v_mfma_f32_16x16x32_bf16 v[216:219], v[84:87], v[64:67], v[216:219]
    ds_read_b64_tr_b16 v[128:129], v12 offset:6144
    s_add_u32 s41, s41, 29696
    s_cmp_eq_u32 s41, 148480
    s_cselect_b32 s41, 0, s41
    v_mfma_f32_16x16x32_bf16 v[220:223], v[88:91], v[52:55], v[220:223]
    ds_read_b64_tr_b16 v[130:131], v12 offset:6400
    s_add_u32 s43, s43, 64
    s_add_u32 s44, s44, s50
    s_cmp_eq_u32 s43, 1280
    s_cselect_b32 s43, 0, s43
    s_cselect_b32 s44, 0, s44
    v_mfma_f32_16x16x32_bf16 v[224:227], v[88:91], v[56:59], v[224:227]
    s_add_u32 s61, s61, 1
    s_cmp_ge_u32 s61, 20
    s_cselect_b32 s43, s54, s43
    s_cselect_b32 s44, s54, s44
    v_mfma_f32_16x16x32_bf16 v[228:231], v[88:91], v[60:63], v[228:231]
    v_add_u32 v9, s42, v5
    v_add_u32 v10, s42, v6
    v_mfma_f32_16x16x32_bf16 v[232:235], v[88:91], v[64:67], v[232:235]
    v_add_u32 v11, s42, v7
    v_add_u32 v12, s42, v8
    s_waitcnt lgkmcnt(15)
    v_mfma_f32_16x16x32_bf16 v[44:47], v[244:247], v[24:27], v[44:47]
    v_add_u32 v255, s42, v253
    v_add_u32 v14, s42, v254
    v_mfma_f32_16x16x32_bf16 v[48:51], v[248:251], v[24:27], v[48:51]
    s_add_u32 s42, s42, 29696
    s_cmp_eq_u32 s42, 148480
    s_cselect_b32 s42, 0, s42
    s_add_u32 s45, s45, 1
    s_waitcnt vmcnt(10) lgkmcnt(0)
    s_barrier
    v_mfma_f32_16x16x32_bf16 v[140:143], v[108:111], v[92:95], v[140:143]
    buffer_load_dword v15, v16, s[80:83], s84 offen
    s_add_u32 s84, s84, s85
    s_add_u32 s87, s87, 1
    s_cmp_eq_u32 s87, 10
    s_cselect_b32 s84, s88, s84
    s_cselect_b32 s87, 0, s87
    ds_read_b64_tr_b16 v[244:245], v255 offset:0
    s_add_u32 m0, s41, s46
    v_mfma_f32_16x16x32_bf16 v[144:147], v[108:111], v[96:99], v[144:147]
    buffer_load_dwordx4 v1, s[8:11], s43 offen lds
    ds_read_b64_tr_b16 v[246:247], v255 offset:256
    v_mfma_f32_16x16x32_bf16 v[148:151], v[108:111], v[100:103], v[148:151]
    ds_read_b64_tr_b16 v[248:249], v14 offset:0
    s_add_u32 m0, s41, s47
    v_mfma_f32_16x16x32_bf16 v[152:155], v[108:111], v[104:107], v[152:155]
    buffer_load_dwordx4 v2, s[8:11], s43 offen lds
    ds_read_b64_tr_b16 v[250:251], v14 offset:256
    v_mfma_f32_16x16x32_bf16 v[156:159], v[112:115], v[92:95], v[156:159]
    ds_read_b128 v[52:55], v9 offset:0
    s_add_u32 m0, s41, s48
    v_mfma_f32_16x16x32_bf16 v[160:163], v[112:115], v[96:99], v[160:163]
    buffer_load_dwordx4 v3, s[12:15], s44 offen lds
    ds_read_b128 v[56:59], v9 offset:1024
    v_mfma_f32_16x16x32_bf16 v[164:167], v[112:115], v[100:103], v[164:167]
    ds_read_b128 v[60:63], v9 offset:2048
    s_add_u32 m0, s41, s49
    v_mfma_f32_16x16x32_bf16 v[168:171], v[112:115], v[104:107], v[168:171]
    buffer_load_dwordx4 v4, s[16:19], s44 offen lds
    ds_read_b128 v[64:67], v9 offset:3072
    v_mfma_f32_16x16x32_bf16 v[172:175], v[116:119], v[92:95], v[172:175]
    ds_read_b64_tr_b16 v[68:69], v10 offset:0
    s_add_u32 s41, s41, 29696
    s_cmp_eq_u32 s41, 148480
    s_cselect_b32 s41, 0, s41
    v_mfma_f32_16x16x32_bf16 v[176:179], v[116:119], v[96:99], v[176:179]
    ds_read_b64_tr_b16 v[70:71], v10 offset:256
    s_add_u32 s43, s43, 64
    s_add_u32 s44, s44, s50
    s_cmp_eq_u32 s43, 1280
    s_cselect_b32 s43, 0, s43
    s_cselect_b32 s44, 0, s44
    v_mfma_f32_16x16x32_bf16 v[180:183], v[116:119], v[100:103], v[180:183]
    s_add_u32 s61, s61, 1
    s_cmp_ge_u32 s61, 20
    s_cselect_b32 s43, s54, s43
    s_cselect_b32 s44, s54, s44
    v_mfma_f32_16x16x32_bf16 v[184:187], v[116:119], v[104:107], v[184:187]
    ds_read_b64_tr_b16 v[72:73], v11 offset:0
    s_add_u32 m0, s41, s46
    v_mfma_f32_16x16x32_bf16 v[188:191], v[120:123], v[92:95], v[188:191]
    buffer_load_dwordx4 v1, s[8:11], s43 offen lds
    ds_read_b64_tr_b16 v[74:75], v11 offset:256
    v_mfma_f32_16x16x32_bf16 v[192:195], v[120:123], v[96:99], v[192:195]
    ds_read_b64_tr_b16 v[76:77], v12 offset:0
    s_add_u32 m0, s41, s47
    v_mfma_f32_16x16x32_bf16 v[196:199], v[120:123], v[100:103], v[196:199]
    buffer_load_dwordx4 v2, s[8:11], s43 offen lds
    ds_read_b64_tr_b16 v[78:79], v12 offset:256
    v_mfma_f32_16x16x32_bf16 v[200:203], v[120:123], v[104:107], v[200:203]
    ds_read_b64_tr_b16 v[80:81], v10 offset:6144
    s_add_u32 m0, s41, s48
    v_mfma_f32_16x16x32_bf16 v[204:207], v[124:127], v[92:95], v[204:207]
    buffer_load_dwordx4 v3, s[12:15], s44 offen lds
    ds_read_b64_tr_b16 v[82:83], v10 offset:6400
    v_mfma_f32_16x16x32_bf16 v[208:211], v[124:127], v[96:99], v[208:211]
    ds_read_b64_tr_b16 v[84:85], v11 offset:6144
    s_add_u32 m0, s41, s49
    v_mfma_f32_16x16x32_bf16 v[212:215], v[124:127], v[100:103], v[212:215]
    buffer_load_dwordx4 v4, s[16:19], s44 offen lds
    ds_read_b64_tr_b16 v[86:87], v11 offset:6400
    v_mfma_f32_16x16x32_bf16 v[216:219], v[124:127], v[104:107], v[216:219]
    ds_read_b64_tr_b16 v[88:89], v12 offset:6144
    s_add_u32 s41, s41, 29696
    s_cmp_eq_u32 s41, 148480
    s_cselect_b32 s41, 0, s41
    v_mfma_f32_16x16x32_bf16 v[220:223], v[128:131], v[92:95], v[220:223]
    ds_read_b64_tr_b16 v[90:91], v12 offset:6400
    s_add_u32 s43, s43, 64
    s_add_u32 s44, s44, s50
    s_cmp_eq_u32 s43, 1280
    s_cselect_b32 s43, 0, s43
    s_cselect_b32 s44, 0, s44
    v_mfma_f32_16x16x32_bf16 v[224:227], v[128:131], v[96:99], v[224:227]
    s_add_u32 s61, s61, 1
    s_cmp_ge_u32 s61, 20
    s_cselect_b32 s43, s54, s43
    s_cselect_b32 s44, s54, s44
    v_mfma_f32_16x16x32_bf16 v[228:231], v[128:131], v[100:103], v[228:231]
    v_add_u32 v9, s42, v5
    v_add_u32 v10, s42, v6
    v_mfma_f32_16x16x32_bf16 v[232:235], v[128:131], v[104:107], v[232:235]
    v_add_u32 v11, s42, v7
    v_add_u32 v12, s42, v8
    s_waitcnt lgkmcnt(15)
    v_mfma_f32_16x16x32_bf16 v[44:47], v[244:247], v[24:27], v[44:47]
    v_add_u32 v255, s42, v253
    v_add_u32 v14, s42, v254
    v_mfma_f32_16x16x32_bf16 v[48:51], v[248:251], v[24:27], v[48:51]
    s_add_u32 s42, s42, 29696
    s_cmp_eq_u32 s42, 148480
    s_cselect_b32 s42, 0, s42
    s_add_u32 s45, s45, 1
    .p2align 3
F_loop:
    s_waitcnt vmcnt(13) lgkmcnt(0)
    s_barrier
    v_mfma_f32_16x16x32_bf16 v[140:143], v[68:71], v[52:55], v[140:143]
    buffer_load_dword v15, v16, s[80:83], s84 offen
    s_add_u32 s84, s84, s85
    s_add_u32 s87, s87, 1
    s_cmp_eq_u32 s87, 10
    s_cselect_b32 s84, s88, s84
    s_cselect_b32 s87, 0, s87
    ds_read_b64_tr_b16 v[244:245], v255 offset:0
    s_add_u32 m0, s41, s46
    v_mfma_f32_16x16x32_bf16 v[144:147], v[68:71], v[56:59], v[144:147]
    buffer_load_dwordx4 v1, s[8:11], s43 offen lds
    ds_read_b64_tr_b16 v[246:247], v255 offset:256
    v_mfma_f32_16x16x32_bf16 v[148:151], v[68:71], v[60:63], v[148:151]
    ds_read_b64_tr_b16 v[248:249], v14 offset:0
    v_mfma_f32_16x16x32_bf16 v[152:155], v[68:71], v[64:67], v[152:155]
    ds_read_b64_tr_b16 v[250:251], v14 offset:256
    v_mfma_f32_16x16x32_bf16 v[156:159], v[72:75], v[52:55], v[156:159]
    ds_read_b128 v[92:95], v9 offset:0
    v_mfma_f32_16x16x32_bf16 v[160:163], v[72:75], v[56:59], v[160:163]
    ds_read_b128 v[96:99], v9 offset:1024
    v_mfma_f32_16x16x32_bf16 v[164:167], v[72:75], v[60:63], v[164:167]
    ds_read_b128 v[100:103], v9 offset:2048
    s_add_u32 m0, s41, s47
    v_mfma_f32_16x16x32_bf16 v[168:171], v[72:75], v[64:67], v[168:171]
    buffer_load_dwordx4 v2, s[8:11], s43 offen lds
    ds_read_b128 v[104:107], v9 offset:3072
    v_mfma_f32_16x16x32_bf16 v[172:175], v[76:79], v[52:55], v[172:175]
    ds_read_b64_tr_b16 v[108:109], v10 offset:0
    v_mfma_f32_16x16x32_bf16 v[176:179], v[76:79], v[56:59], v[176:179]
    ds_read_b64_tr_b16 v[110:111], v10 offset:256
    v_mfma_f32_16x16x32_bf16 v[180:183], v[76:79], v[60:63], v[180:183]
    v_mfma_f32_16x16x32_bf16 v[184:187], v[76:79], v[64:67], v[184:187]
    ds_read_b64_tr_b16 v[112:113], v11 offset:0
    v_mfma_f32_16x16x32_bf16 v[188:191], v[80:83], v[52:55], v[188:191]
    ds_read_b64_tr_b16 v[114:115], v11 offset:256
    s_add_u32 m0, s41, s48
    v_mfma_f32_16x16x32_bf16 v[192:195], v[80:83], v[56:59], v[192:195]
    buffer_load_dwordx4 v3, s[12:15], s44 offen lds
    ds_read_b64_tr_b16 v[116:117], v12 offset:0
    v_mfma_f32_16x16x32_bf16 v[196:199], v[80:83], v[60:63], v[196:199]
    ds_read_b64_tr_b16 v[118:119], v12 offset:256
    v_mfma_f32_16x16x32_bf16 v[200:203], v[80:83], v[64:67], v[200:203]
    ds_read_b64_tr_b16 v[120:121], v10 offset:6144
    v_mfma_f32_16x16x32_bf16 v[204:207], v[84:87], v[52:55], v[204:207]
    ds_read_b64_tr_b16 v[122:123], v10 offset:6400
    v_mfma_f32_16x16x32_bf16 v[208:211], v[84:87], v[56:59], v[208:211]
    ds_read_b64_tr_b16 v[124:125], v11 offset:6144
    v_mfma_f32_16x16x32_bf16 v[212:215], v[84:87], v[60:63], v[212:215]
    ds_read_b64_tr_b16 v[126:127], v11 offset:6400
    s_add_u32 m0, s41, s49
    v_mfma_f32_16x16x32_bf16 v[216:219], v[84:87], v[64:67], v[216:219]
    buffer_load_dwordx4 v4, s[16:19], s44 offen lds
    ds_read_b64_tr_b16 v[128:129], v12 offset:6144
    v_mfma_f32_16x16x32_bf16 v[220:223], v[88:91], v[52:55], v[220:223]
    ds_read_b64_tr_b16 v[130:131], v12 offset:6400
    s_add_u32 s41, s41, 29696
    s_cmp_eq_u32 s41, 148480
    s_cselect_b32 s41, 0, s41
    v_mfma_f32_16x16x32_bf16 v[224:227], v[88:91], v[56:59], v[224:227]
    s_add_u32 s43, s43, 64
    s_add_u32 s44, s44, s50
    s_cmp_eq_u32 s43, 1280
    s_cselect_b32 s43, 0, s43
    s_cselect_b32 s44, 0, s44
    v_mfma_f32_16x16x32_bf16 v[228:231], v[88:91], v[60:63], v[228:231]
    s_add_u32 s61, s61, 1
    s_cmp_ge_u32 s61, 20
    s_cselect_b32 s43, s54, s43
    s_cselect_b32 s44, s54, s44
    v_mfma_f32_16x16x32_bf16 v[232:235], v[88:91], v[64:67], v[232:235]
    v_add_u32 v9, s42, v5
    v_add_u32 v10, s42, v6
    s_waitcnt lgkmcnt(15)
    v_mfma_f32_16x16x32_bf16 v[44:47], v[244:247], v[24:27], v[44:47]
    v_add_u32 v11, s42, v7
    v_add_u32 v12, s42, v8
    v_add_u32 v255, s42, v253
    v_add_u32 v14, s42, v254
    v_mfma_f32_16x16x32_bf16 v[48:51], v[248:251], v[24:27], v[48:51]
    s_add_u32 s42, s42, 29696
    s_cmp_eq_u32 s42, 148480
    s_cselect_b32 s42, 0, s42
    s_add_u32 s45, s45, 1
    s_waitcnt vmcnt(14) lgkmcnt(0)
    s_barrier
    v_mfma_f32_16x16x32_bf16 v[140:143], v[108:111], v[92:95], v[140:143]
    ds_read_b64_tr_b16 v[244:245], v255 offset:0
    s_add_u32 m0, s41, s46
    v_mfma_f32_16x16x32_bf16 v[144:147], v[108:111], v[96:99], v[144:147]
    buffer_load_dwordx4 v1, s[8:11], s43 offen lds
    ds_read_b64_tr_b16 v[246:247], v255 offset:256
    v_mfma_f32_16x16x32_bf16 v[148:151], v[108:111], v[100:103], v[148:151]
    ds_read_b64_tr_b16 v[248:249], v14 offset:0
    v_mfma_f32_16x16x32_bf16 v[152:155], v[108:111], v[104:107], v[152:155]
    ds_read_b64_tr_b16 v[250:251], v14 offset:256
    v_mfma_f32_16x16x32_bf16 v[156:159], v[112:115], v[92:95], v[156:159]
    ds_read_b128 v[52:55], v9 offset:0
    v_mfma_f32_16x16x32_bf16 v[160:163], v[112:115], v[96:99], v[160:163]
    ds_read_b128 v[56:59], v9 offset:1024
    v_mfma_f32_16x16x32_bf16 v[164:167], v[112:115], v[100:103], v[164:167]
    ds_read_b128 v[60:63], v9 offset:2048
    s_add_u32 m0, s41, s47
    v_mfma_f32_16x16x32_bf16 v[168:171], v[112:115], v[104:107], v[168:171]
    buffer_load_dwordx4 v2, s[8:11], s43 offen lds
    ds_read_b128 v[64:67], v9 offset:3072
    v_mfma_f32_16x16x32_bf16 v[172:175], v[116:119], v[92:95], v[172:175]
    ds_read_b64_tr_b16 v[68:69], v10 offset:0
    v_mfma_f32_16x16x32_bf16 v[176:179], v[116:119], v[96:99], v[176:179]
    ds_read_b64_tr_b16 v[70:71], v10 offset:256
    v_mfma_f32_16x16x32_bf16 v[180:183], v[116:119], v[100:103], v[180:183]
    v_mfma_f32_16x16x32_bf16 v[184:187], v[116:119], v[104:107], v[184:187]
    ds_read_b64_tr_b16 v[72:73], v11 offset:0
    v_mfma_f32_16x16x32_bf16 v[188:191], v[120:123], v[92:95], v[188:191]
    ds_read_b64_tr_b16 v[74:75], v11 offset:256
    s_add_u32 m0, s41, s48
    v_mfma_f32_16x16x32_bf16 v[192:195], v[120:123], v[96:99], v[192:195]
    buffer_load_dwordx4 v3, s[12:15], s44 offen lds
    ds_read_b64_tr_b16 v[76:77], v12 offset:0
    v_mfma_f32_16x16x32_bf16 v[196:199], v[120:123], v[100:103], v[196:199]
    ds_read_b64_tr_b16 v[78:79], v12 offset:256
    v_mfma_f32_16x16x32_bf16 v[200:203], v[120:123], v[104:107], v[200:203]
    ds_read_b64_tr_b16 v[80:81], v10 offset:6144
    v_mfma_f32_16x16x32_bf16 v[204:207], v[124:127], v[92:95], v[204:207]
    ds_read_b64_tr_b16 v[82:83], v10 offset:6400
    v_mfma_f32_16x16x32_bf16 v[208:211], v[124:127], v[96:99], v[208:211]
    ds_read_b64_tr_b16 v[84:85], v11 offset:6144
    v_mfma_f32_16x16x32_bf16 v[212:215], v[124:127], v[100:103], v[212:215]
    ds_read_b64_tr_b16 v[86:87], v11 offset:6400
    s_add_u32 m0, s41, s49
    v_mfma_f32_16x16x32_bf16 v[216:219], v[124:127], v[104:107], v[216:219]
    buffer_load_dwordx4 v4, s[16:19], s44 offen lds
    ds_read_b64_tr_b16 v[88:89], v12 offset:6144
    v_mfma_f32_16x16x32_bf16 v[220:223], v[128:131], v[92:95], v[220:223]
    ds_read_b64_tr_b16 v[90:91], v12 offset:6400
    s_add_u32 s41, s41, 29696
    s_cmp_eq_u32 s41, 148480
    s_cselect_b32 s41, 0, s41
    v_mfma_f32_16x16x32_bf16 v[224:227], v[128:131], v[96:99], v[224:227]
    s_add_u32 s43, s43, 64
    s_add_u32 s44, s44, s50
    s_cmp_eq_u32 s43, 1280
    s_cselect_b32 s43, 0, s43
    s_cselect_b32 s44, 0, s44
    v_mfma_f32_16x16x32_bf16 v[228:231], v[128:131], v[100:103], v[228:231]
    s_add_u32 s61, s61, 1
    s_cmp_ge_u32 s61, 20
    s_cselect_b32 s43, s54, s43
    s_cselect_b32 s44, s54, s44
    v_mfma_f32_16x16x32_bf16 v[232:235], v[128:131], v[104:107], v[232:235]
    v_add_u32 v9, s42, v5
    v_add_u32 v10, s42, v6
    s_waitcnt lgkmcnt(15)
    v_mfma_f32_16x16x32_bf16 v[44:47], v[244:247], v[24:27], v[44:47]
    v_add_u32 v11, s42, v7
    v_add_u32 v12, s42, v8
    v_add_u32 v255, s42, v253
    v_add_u32 v14, s42, v254
    v_mfma_f32_16x16x32_bf16 v[48:51], v[248:251], v[24:27], v[48:51]
    s_add_u32 s42, s42, 29696
    s_cmp_eq_u32 s42, 148480
    s_cselect_b32 s42, 0, s42
    s_add_u32 s45, s45, 1
    s_cmp_lt_u32 s45, 18
    s_cbranch_scc1 F_loop
    s_waitcnt vmcnt(13) lgkmcnt(0)
    s_barrier
    v_mfma_f32_16x16x32_bf16 v[140:143], v[68:71], v[52:55], v[140:143]
    ds_read_b64_tr_b16 v[244:245], v255 offset:0
    buffer_load_dword v15, v17, s[24:27], 0 offen sc1
    v_mfma_f32_16x16x32_bf16 v[144:147], v[68:71], v[56:59], v[144:147]
    ds_read_b64_tr_b16 v[246:247], v255 offset:256
    v_mfma_f32_16x16x32_bf16 v[148:151], v[68:71], v[60:63], v[148:151]
    ds_read_b64_tr_b16 v[248:249], v14 offset:0
    v_mfma_f32_16x16x32_bf16 v[152:155], v[68:71], v[64:67], v[152:155]
    ds_read_b64_tr_b16 v[250:251], v14 offset:256
    v_mfma_f32_16x16x32_bf16 v[156:159], v[72:75], v[52:55], v[156:159]
    ds_read_b128 v[92:95], v9 offset:0
    v_mfma_f32_16x16x32_bf16 v[160:163], v[72:75], v[56:59], v[160:163]
    ds_read_b128 v[96:99], v9 offset:1024
    v_mfma_f32_16x16x32_bf16 v[164:167], v[72:75], v[60:63], v[164:167]
    ds_read_b128 v[100:103], v9 offset:2048
    v_mfma_f32_16x16x32_bf16 v[168:171], v[72:75], v[64:67], v[168:171]
    ds_read_b128 v[104:107], v9 offset:3072
    v_mfma_f32_16x16x32_bf16 v[172:175], v[76:79], v[52:55], v[172:175]
    ds_read_b64_tr_b16 v[108:109], v10 offset:0
    v_mfma_f32_16x16x32_bf16 v[176:179], v[76:79], v[56:59], v[176:179]
    ds_read_b64_tr_b16 v[110:111], v10 offset:256
    v_mfma_f32_16x16x32_bf16 v[180:183], v[76:79], v[60:63], v[180:183]
    v_mfma_f32_16x16x32_bf16 v[184:187], v[76:79], v[64:67], v[184:187]
    ds_read_b64_tr_b16 v[112:113], v11 offset:0
    v_mfma_f32_16x16x32_bf16 v[188:191], v[80:83], v[52:55], v[188:191]
    ds_read_b64_tr_b16 v[114:115], v11 offset:256
    v_mfma_f32_16x16x32_bf16 v[192:195], v[80:83], v[56:59], v[192:195]
    ds_read_b64_tr_b16 v[116:117], v12 offset:0
    v_mfma_f32_16x16x32_bf16 v[196:199], v[80:83], v[60:63], v[196:199]
    ds_read_b64_tr_b16 v[118:119], v12 offset:256
    v_mfma_f32_16x16x32_bf16 v[200:203], v[80:83], v[64:67], v[200:203]
    ds_read_b64_tr_b16 v[120:121], v10 offset:6144
    v_mfma_f32_16x16x32_bf16 v[204:207], v[84:87], v[52:55], v[204:207]
    ds_read_b64_tr_b16 v[122:123], v10 offset:6400
    v_mfma_f32_16x16x32_bf16 v[208:211], v[84:87], v[56:59], v[208:211]
    ds_read_b64_tr_b16 v[124:125], v11 offset:6144
    v_mfma_f32_16x16x32_bf16 v[212:215], v[84:87], v[60:63], v[212:215]
    ds_read_b64_tr_b16 v[126:127], v11 offset:6400
    v_mfma_f32_16x16x32_bf16 v[216:219], v[84:87], v[64:67], v[216:219]
    ds_read_b64_tr_b16 v[128:129], v12 offset:6144
    v_mfma_f32_16x16x32_bf16 v[220:223], v[88:91], v[52:55], v[220:223]
    ds_read_b64_tr_b16 v[130:131], v12 offset:6400
    v_mfma_f32_16x16x32_bf16 v[224:227], v[88:91], v[56:59], v[224:227]
    v_add_u32 v9, s42, v5
    v_add_u32 v10, s42, v6
    v_mfma_f32_16x16x32_bf16 v[228:231], v[88:91], v[60:63], v[228:231]
    v_add_u32 v11, s42, v7
    v_add_u32 v12, s42, v8
    v_mfma_f32_16x16x32_bf16 v[232:235], v[88:91], v[64:67], v[232:235]
    v_add_u32 v255, s42, v253
    v_add_u32 v14, s42, v254
    s_waitcnt lgkmcnt(15)
    v_mfma_f32_16x16x32_bf16 v[44:47], v[244:247], v[24:27], v[44:47]
    v_mfma_f32_16x16x32_bf16 v[48:51], v[248:251], v[24:27], v[48:51]
    s_add_u32 s42, s42, 29696
    s_cmp_eq_u32 s42, 148480
    s_cselect_b32 s42, 0, s42
    s_add_u32 s45, s45, 1
    s_waitcnt vmcnt(0) lgkmcnt(0)
    s_barrier
    v_mfma_f32_16x16x32_bf16 v[140:143], v[108:111], v[92:95], v[140:143]
    ds_read_b64_tr_b16 v[244:245], v255 offset:0
    v_readfirstlane_b32 s61, v15
    s_mov_b32 s60, 0
F_chk:
    s_cmp_ge_u32 s61, 16
    s_cbranch_scc1 F_ok
    s_sleep 16
    buffer_load_dword v15, v17, s[24:27], 0 offen sc1
    s_waitcnt vmcnt(0)
    v_readfirstlane_b32 s61, v15
    s_add_u32 s60, s60, 1
    s_cmp_lt_u32 s60, 0x100000
    s_cbranch_scc1 F_chk
F_ok:
    buffer_load_dwordx4 v[28:31], v18, s[28:31], 0 offen sc1
    buffer_load_dwordx4 v[32:35], v19, s[28:31], 0 offen sc1
    buffer_load_dwordx4 v[36:39], v20, s[28:31], 0 offen sc1
    buffer_load_dwordx4 v[40:43], v21, s[28:31], 0 offen sc1
    v_mfma_f32_16x16x32_bf16 v[144:147], v[108:111], v[96:99], v[144:147]
    ds_read_b64_tr_b16 v[246:247], v255 offset:256
    v_mfma_f32_16x16x32_bf16 v[148:151], v[108:111], v[100:103], v[148:151]
    ds_read_b64_tr_b16 v[248:249], v14 offset:0
    v_mfma_f32_16x16x32_bf16 v[152:155], v[108:111], v[104:107], v[152:155]
    ds_read_b64_tr_b16 v[250:251], v14 offset:256
    v_mfma_f32_16x16x32_bf16 v[156:159], v[112:115], v[92:95], v[156:159]
    ds_read_b128 v[52:55], v9 offset:0
    v_mfma_f32_16x16x32_bf16 v[160:163], v[112:115], v[96:99], v[160:163]
    ds_read_b128 v[56:59], v9 offset:1024
    v_mfma_f32_16x16x32_bf16 v[164:167], v[112:115], v[100:103], v[164:167]
    ds_read_b128 v[60:63], v9 offset:2048
    v_mfma_f32_16x16x32_bf16 v[168:171], v[112:115], v[104:107], v[168:171]
    ds_read_b128 v[64:67], v9 offset:3072
    v_mfma_f32_16x16x32_bf16 v[172:175], v[116:119], v[92:95], v[172:175]
    ds_read_b64_tr_b16 v[68:69], v10 offset:0
    v_mfma_f32_16x16x32_bf16 v[176:179], v[116:119], v[96:99], v[176:179]
    ds_read_b64_tr_b16 v[70:71], v10 offset:256
    v_mfma_f32_16x16x32_bf16 v[180:183], v[116:119], v[100:103], v[180:183]
    v_mfma_f32_16x16x32_bf16 v[184:187], v[116:119], v[104:107], v[184:187]
    ds_read_b64_tr_b16 v[72:73], v11 offset:0
    v_mfma_f32_16x16x32_bf16 v[188:191], v[120:123], v[92:95], v[188:191]
    ds_read_b64_tr_b16 v[74:75], v11 offset:256
    v_mfma_f32_16x16x32_bf16 v[192:195], v[120:123], v[96:99], v[192:195]
    ds_read_b64_tr_b16 v[76:77], v12 offset:0
    v_mfma_f32_16x16x32_bf16 v[196:199], v[120:123], v[100:103], v[196:199]
    ds_read_b64_tr_b16 v[78:79], v12 offset:256
    v_mfma_f32_16x16x32_bf16 v[200:203], v[120:123], v[104:107], v[200:203]
    ds_read_b64_tr_b16 v[80:81], v10 offset:6144
    v_mfma_f32_16x16x32_bf16 v[204:207], v[124:127], v[92:95], v[204:207]
    ds_read_b64_tr_b16 v[82:83], v10 offset:6400
    v_mfma_f32_16x16x32_bf16 v[208:211], v[124:127], v[96:99], v[208:211]
    ds_read_b64_tr_b16 v[84:85], v11 offset:6144
    v_mfma_f32_16x16x32_bf16 v[212:215], v[124:127], v[100:103], v[212:215]
    ds_read_b64_tr_b16 v[86:87], v11 offset:6400
    v_mfma_f32_16x16x32_bf16 v[216:219], v[124:127], v[104:107], v[216:219]
    ds_read_b64_tr_b16 v[88:89], v12 offset:6144
    v_mfma_f32_16x16x32_bf16 v[220:223], v[128:131], v[92:95], v[220:223]
    ds_read_b64_tr_b16 v[90:91], v12 offset:6400
    v_mfma_f32_16x16x32_bf16 v[224:227], v[128:131], v[96:99], v[224:227]
    v_add_u32 v9, s42, v5
    v_add_u32 v10, s42, v6
    v_mfma_f32_16x16x32_bf16 v[228:231], v[128:131], v[100:103], v[228:231]
    v_add_u32 v11, s42, v7
    v_add_u32 v12, s42, v8
    v_mfma_f32_16x16x32_bf16 v[232:235], v[128:131], v[104:107], v[232:235]
    v_add_u32 v255, s42, v253
    v_add_u32 v14, s42, v254
    s_waitcnt lgkmcnt(15)
    v_mfma_f32_16x16x32_bf16 v[44:47], v[244:247], v[24:27], v[44:47]
    v_mfma_f32_16x16x32_bf16 v[48:51], v[248:251], v[24:27], v[48:51]
    s_add_u32 s42, s42, 29696
    s_cmp_eq_u32 s42, 148480
    s_cselect_b32 s42, 0, s42
    s_add_u32 s45, s45, 1
    s_waitcnt vmcnt(0) lgkmcnt(0)
    s_barrier
    s_nop 7
    v_and_b32 v18, 15, v0
    v_lshrrev_b32 v17, 4, v0
    s_lshl_b32 s51, s40, 9
    s_add_u32 s51, s51, 152576
    v_lshlrev_b32 v16, 4, v17
    v_add_u32 v16, s51, v16
    s_lshl_b32 s51, s39, 7
    v_add_u32 v19, s51, v16
    v_cmp_eq_u32 vcc, 0, v18
    s_nop 1
    s_and_saveexec_b64 s[62:63], vcc
    s_cmp_eq_u32 s39, 3
    s_cbranch_scc1 F_nocs
    ds_write_b128 v19, v[44:47]
    ds_write_b128 v19, v[48:51] offset:64
F_nocs:
    s_mov_b64 exec, s[62:63]
    s_waitcnt lgkmcnt(0)
    s_barrier
    ds_read_b128 v[68:71], v16 offset:0
    ds_read_b128 v[72:75], v16 offset:64
    ds_read_b128 v[76:79], v16 offset:128
    ds_read_b128 v[80:83], v16 offset:192
    ds_read_b128 v[84:87], v16 offset:256
    ds_read_b128 v[88:91], v16 offset:320
    s_lshl_b32 s51, s36, 4
    s_lshl_b32 s55, s39, 2
    s_add_u32 s51, s51, s55
    s_lshl_b32 s51, s51, 10
    v_lshlrev_b32 v14, 4, v0
    v_add_u32 v14, s51, v14
    s_mul_i32 s51, s37, 3
    s_add_u32 s51, s51, 20
    s_lshl_b32 s55, s40, 1
    s_add_u32 s55, s55, s51
    s_lshl_b32 s55, s55, 17
    s_add_u32 s56, s51, 1
    s_lshl_b32 s56, s56, 17
    s_lshl_b32 s57, s40, 3
    s_add_u32 s56, s56, s57
    s_waitcnt lgkmcnt(0)
    v_fma_f32 v140, v28, v68, v140
    v_fma_f32 v141, v28, v69, v141
    v_fma_f32 v142, v28, v70, v142
    v_fma_f32 v143, v28, v71, v143
    v_fma_f32 v188, v28, v80, v188
    v_fma_f32 v189, v28, v81, v189
    v_fma_f32 v190, v28, v82, v190
    v_fma_f32 v191, v28, v83, v191
    v_mul_f32 v100, v140, v140
    v_mul_f32 v101, v141, v141
    v_mul_f32 v102, v142, v142
    v_mul_f32 v103, v143, v143
    v_fma_f32 v100, v100, v30, v29
    v_fma_f32 v101, v101, v30, v29
    v_fma_f32 v102, v102, v30, v29
    v_fma_f32 v103, v103, v30, v29
    v_mul_f32 v100, v100, v140
    v_mul_f32 v101, v101, v141
    v_mul_f32 v102, v102, v142
    v_mul_f32 v103, v103, v143
    v_exp_f32 v100, v100
    v_exp_f32 v101, v101
    v_exp_f32 v102, v102
    v_exp_f32 v103, v103
    v_mul_f32 v140, v140, v188
    v_mul_f32 v141, v141, v189
    v_mul_f32 v142, v142, v190
    v_mul_f32 v143, v143, v191
    v_fma_f32 v100, v100, v31, v31
    v_fma_f32 v101, v101, v31, v31
    v_fma_f32 v102, v102, v31, v31
    v_fma_f32 v103, v103, v31, v31
    v_rcp_f32 v100, v100
    v_rcp_f32 v101, v101
    v_rcp_f32 v102, v102
    v_rcp_f32 v103, v103
    s_nop 0
    v_mul_f32 v140, v140, v100
    v_mul_f32 v141, v141, v101
    v_mul_f32 v142, v142, v102
    v_mul_f32 v143, v143, v103
    v_cvt_pk_bf16_f32 v104, v140, v141
    v_cvt_pk_bf16_f32 v105, v142, v143
    v_fma_f32 v156, v28, v72, v156
    v_fma_f32 v157, v28, v73, v157
    v_fma_f32 v158, v28, v74, v158
    v_fma_f32 v159, v28, v75, v159
    v_fma_f32 v204, v28, v84, v204
    v_fma_f32 v205, v28, v85, v205
    v_fma_f32 v206, v28, v86, v206
    v_fma_f32 v207, v28, v87, v207
    v_mul_f32 v100, v156, v156
    v_mul_f32 v101, v157, v157
    v_mul_f32 v102, v158, v158
    v_mul_f32 v103, v159, v159
    v_fma_f32 v100, v100, v30, v29
    v_fma_f32 v101, v101, v30, v29
    v_fma_f32 v102, v102, v30, v29
    v_fma_f32 v103, v103, v30, v29
    v_mul_f32 v100, v100, v156
    v_mul_f32 v101, v101, v157
    v_mul_f32 v102, v102, v158
    v_mul_f32 v103, v103, v159
    v_exp_f32 v100, v100
    v_exp_f32 v101, v101
    v_exp_f32 v102, v102
    v_exp_f32 v103, v103
    v_mul_f32 v156, v156, v204
    v_mul_f32 v157, v157, v205
    v_mul_f32 v158, v158, v206
    v_mul_f32 v159, v159, v207
    v_fma_f32 v100, v100, v31, v31
    v_fma_f32 v101, v101, v31, v31
    v_fma_f32 v102, v102, v31, v31
    v_fma_f32 v103, v103, v31, v31
    v_rcp_f32 v100, v100
    v_rcp_f32 v101, v101
    v_rcp_f32 v102, v102
    v_rcp_f32 v103, v103
    s_nop 0
    v_mul_f32 v156, v156, v100
    v_mul_f32 v157, v157, v101
    v_mul_f32 v158, v158, v102
    v_mul_f32 v159, v159, v103
    v_cvt_pk_bf16_f32 v106, v156, v157
    v_cvt_pk_bf16_f32 v107, v158, v159
    v_fma_f32 v172, v28, v76, v172
    v_fma_f32 v173, v28, v77, v173
    v_fma_f32 v174, v28, v78, v174
    v_fma_f32 v175, v28, v79, v175
    v_fma_f32 v220, v28, v88, v220
    v_fma_f32 v221, v28, v89, v221
    v_fma_f32 v222, v28, v90, v222
    v_fma_f32 v223, v28, v91, v223
    v_mul_f32 v100, v172, v172
    v_mul_f32 v101, v173, v173
    v_mul_f32 v102, v174, v174
    v_mul_f32 v103, v175, v175
    v_fma_f32 v100, v100, v30, v29
    v_fma_f32 v101, v101, v30, v29
    v_fma_f32 v102, v102, v30, v29
    v_fma_f32 v103, v103, v30, v29
    v_mul_f32 v100, v100, v172
    v_mul_f32 v101, v101, v173
    v_mul_f32 v102, v102, v174
    v_mul_f32 v103, v103, v175
    v_exp_f32 v100, v100
    v_exp_f32 v101, v101
    v_exp_f32 v102, v102
    v_exp_f32 v103, v103
    v_mul_f32 v172, v172, v220
    v_mul_f32 v173, v173, v221
    v_mul_f32 v174, v174, v222
    v_mul_f32 v175, v175, v223
    v_fma_f32 v100, v100, v31, v31
    v_fma_f32 v101, v101, v31, v31
    v_fma_f32 v102, v102, v31, v31
    v_fma_f32 v103, v103, v31, v31
    v_rcp_f32 v100, v100
    v_rcp_f32 v101, v101
    v_rcp_f32 v102, v102
    v_rcp_f32 v103, v103
    s_nop 0
    v_mul_f32 v172, v172, v100
    v_mul_f32 v173, v173, v101
    v_mul_f32 v174, v174, v102
    v_mul_f32 v175, v175, v103
    v_cvt_pk_bf16_f32 v108, v172, v173
    v_cvt_pk_bf16_f32 v109, v174, v175
    buffer_store_dwordx4 v[104:107], v14, s[20:23], s55 offen offset:0 sc1
    buffer_store_dwordx2 v[108:109], v14, s[20:23], s56 offen offset:0 sc1
    v_fma_f32 v144, v32, v68, v144
    v_fma_f32 v145, v32, v69, v145
    v_fma_f32 v146, v32, v70, v146
    v_fma_f32 v147, v32, v71, v147
    v_fma_f32 v192, v32, v80, v192
    v_fma_f32 v193, v32, v81, v193
    v_fma_f32 v194, v32, v82, v194
    v_fma_f32 v195, v32, v83, v195
    v_mul_f32 v100, v144, v144
    v_mul_f32 v101, v145, v145
    v_mul_f32 v102, v146, v146
    v_mul_f32 v103, v147, v147
    v_fma_f32 v100, v100, v34, v33
    v_fma_f32 v101, v101, v34, v33
    v_fma_f32 v102, v102, v34, v33
    v_fma_f32 v103, v103, v34, v33
    v_mul_f32 v100, v100, v144
    v_mul_f32 v101, v101, v145
    v_mul_f32 v102, v102, v146
    v_mul_f32 v103, v103, v147
    v_exp_f32 v100, v100
    v_exp_f32 v101, v101
    v_exp_f32 v102, v102
    v_exp_f32 v103, v103
    v_mul_f32 v144, v144, v192
    v_mul_f32 v145, v145, v193
    v_mul_f32 v146, v146, v194
    v_mul_f32 v147, v147, v195
    v_fma_f32 v100, v100, v35, v35
    v_fma_f32 v101, v101, v35, v35
    v_fma_f32 v102, v102, v35, v35
    v_fma_f32 v103, v103, v35, v35
    v_rcp_f32 v100, v100
    v_rcp_f32 v101, v101
    v_rcp_f32 v102, v102
    v_rcp_f32 v103, v103
    s_nop 0
    v_mul_f32 v144, v144, v100
    v_mul_f32 v145, v145, v101
    v_mul_f32 v146, v146, v102
    v_mul_f32 v147, v147, v103
    v_cvt_pk_bf16_f32 v112, v144, v145
    v_cvt_pk_bf16_f32 v113, v146, v147
    v_fma_f32 v160, v32, v72, v160
    v_fma_f32 v161, v32, v73, v161
    v_fma_f32 v162, v32, v74, v162
    v_fma_f32 v163, v32, v75, v163
    v_fma_f32 v208, v32, v84, v208
    v_fma_f32 v209, v32, v85, v209
    v_fma_f32 v210, v32, v86, v210
    v_fma_f32 v211, v32, v87, v211
    v_mul_f32 v100, v160, v160
    v_mul_f32 v101, v161, v161
    v_mul_f32 v102, v162, v162
    v_mul_f32 v103, v163, v163
    v_fma_f32 v100, v100, v34, v33
    v_fma_f32 v101, v101, v34, v33
    v_fma_f32 v102, v102, v34, v33
    v_fma_f32 v103, v103, v34, v33
    v_mul_f32 v100, v100, v160
    v_mul_f32 v101, v101, v161
    v_mul_f32 v102, v102, v162
    v_mul_f32 v103, v103, v163
    v_exp_f32 v100, v100
    v_exp_f32 v101, v101
    v_exp_f32 v102, v102
    v_exp_f32 v103, v103
    v_mul_f32 v160, v160, v208
    v_mul_f32 v161, v161, v209
    v_mul_f32 v162, v162, v210
    v_mul_f32 v163, v163, v211
    v_fma_f32 v100, v100, v35, v35
    v_fma_f32 v101, v101, v35, v35
    v_fma_f32 v102, v102, v35, v35
    v_fma_f32 v103, v103, v35, v35
    v_rcp_f32 v100, v100
    v_rcp_f32 v101, v101
    v_rcp_f32 v102, v102
    v_rcp_f32 v103, v103
    s_nop 0
    v_mul_f32 v160, v160, v100
    v_mul_f32 v161, v161, v101
    v_mul_f32 v162, v162, v102
    v_mul_f32 v163, v163, v103
    v_cvt_pk_bf16_f32 v114, v160, v161
    v_cvt_pk_bf16_f32 v115, v162, v163
    v_fma_f32 v176, v32, v76, v176
    v_fma_f32 v177, v32, v77, v177
    v_fma_f32 v178, v32, v78, v178
    v_fma_f32 v179, v32, v79, v179
    v_fma_f32 v224, v32, v88, v224
    v_fma_f32 v225, v32, v89, v225
    v_fma_f32 v226, v32, v90, v226
    v_fma_f32 v227, v32, v91, v227
    v_mul_f32 v100, v176, v176
    v_mul_f32 v101, v177, v177
    v_mul_f32 v102, v178, v178
    v_mul_f32 v103, v179, v179
    v_fma_f32 v100, v100, v34, v33
    v_fma_f32 v101, v101, v34, v33
    v_fma_f32 v102, v102, v34, v33
    v_fma_f32 v103, v103, v34, v33
    v_mul_f32 v100, v100, v176
    v_mul_f32 v101, v101, v177
    v_mul_f32 v102, v102, v178
    v_mul_f32 v103, v103, v179
    v_exp_f32 v100, v100
    v_exp_f32 v101, v101
    v_exp_f32 v102, v102
    v_exp_f32 v103, v103
    v_mul_f32 v176, v176, v224
    v_mul_f32 v177, v177, v225
    v_mul_f32 v178, v178, v226
    v_mul_f32 v179, v179, v227
    v_fma_f32 v100, v100, v35, v35
    v_fma_f32 v101, v101, v35, v35
    v_fma_f32 v102, v102, v35, v35
    v_fma_f32 v103, v103, v35, v35
    v_rcp_f32 v100, v100
    v_rcp_f32 v101, v101
    v_rcp_f32 v102, v102
    v_rcp_f32 v103, v103
    s_nop 0
    v_mul_f32 v176, v176, v100
    v_mul_f32 v177, v177, v101
    v_mul_f32 v178, v178, v102
    v_mul_f32 v179, v179, v103
    v_cvt_pk_bf16_f32 v116, v176, v177
    v_cvt_pk_bf16_f32 v117, v178, v179
    buffer_store_dwordx4 v[112:115], v14, s[20:23], s55 offen offset:1024 sc1
    buffer_store_dwordx2 v[116:117], v14, s[20:23], s56 offen offset:1024 sc1
    v_fma_f32 v148, v36, v68, v148
    v_fma_f32 v149, v36, v69, v149
    v_fma_f32 v150, v36, v70, v150
    v_fma_f32 v151, v36, v71, v151
    v_fma_f32 v196, v36, v80, v196
    v_fma_f32 v197, v36, v81, v197
    v_fma_f32 v198, v36, v82, v198
    v_fma_f32 v199, v36, v83, v199
    v_mul_f32 v100, v148, v148
    v_mul_f32 v101, v149, v149
    v_mul_f32 v102, v150, v150
    v_mul_f32 v103, v151, v151
    v_fma_f32 v100, v100, v38, v37
    v_fma_f32 v101, v101, v38, v37
    v_fma_f32 v102, v102, v38, v37
    v_fma_f32 v103, v103, v38, v37
    v_mul_f32 v100, v100, v148
    v_mul_f32 v101, v101, v149
    v_mul_f32 v102, v102, v150
    v_mul_f32 v103, v103, v151
    v_exp_f32 v100, v100
    v_exp_f32 v101, v101
    v_exp_f32 v102, v102
    v_exp_f32 v103, v103
    v_mul_f32 v148, v148, v196
    v_mul_f32 v149, v149, v197
    v_mul_f32 v150, v150, v198
    v_mul_f32 v151, v151, v199
    v_fma_f32 v100, v100, v39, v39
    v_fma_f32 v101, v101, v39, v39
    v_fma_f32 v102, v102, v39, v39
    v_fma_f32 v103, v103, v39, v39
    v_rcp_f32 v100, v100
    v_rcp_f32 v101, v101
    v_rcp_f32 v102, v102
    v_rcp_f32 v103, v103
    s_nop 0
    v_mul_f32 v148, v148, v100
    v_mul_f32 v149, v149, v101
    v_mul_f32 v150, v150, v102
    v_mul_f32 v151, v151, v103
    v_cvt_pk_bf16_f32 v120, v148, v149
    v_cvt_pk_bf16_f32 v121, v150, v151
    v_fma_f32 v164, v36, v72, v164
    v_fma_f32 v165, v36, v73, v165
    v_fma_f32 v166, v36, v74, v166
    v_fma_f32 v167, v36, v75, v167
    v_fma_f32 v212, v36, v84, v212
    v_fma_f32 v213, v36, v85, v213
    v_fma_f32 v214, v36, v86, v214
    v_fma_f32 v215, v36, v87, v215
    v_mul_f32 v100, v164, v164
    v_mul_f32 v101, v165, v165
    v_mul_f32 v102, v166, v166
    v_mul_f32 v103, v167, v167
    v_fma_f32 v100, v100, v38, v37
    v_fma_f32 v101, v101, v38, v37
    v_fma_f32 v102, v102, v38, v37
    v_fma_f32 v103, v103, v38, v37
    v_mul_f32 v100, v100, v164
    v_mul_f32 v101, v101, v165
    v_mul_f32 v102, v102, v166
    v_mul_f32 v103, v103, v167
    v_exp_f32 v100, v100
    v_exp_f32 v101, v101
    v_exp_f32 v102, v102
    v_exp_f32 v103, v103
    v_mul_f32 v164, v164, v212
    v_mul_f32 v165, v165, v213
    v_mul_f32 v166, v166, v214
    v_mul_f32 v167, v167, v215
    v_fma_f32 v100, v100, v39, v39
    v_fma_f32 v101, v101, v39, v39
    v_fma_f32 v102, v102, v39, v39
    v_fma_f32 v103, v103, v39, v39
    v_rcp_f32 v100, v100
    v_rcp_f32 v101, v101
    v_rcp_f32 v102, v102
    v_rcp_f32 v103, v103
    s_nop 0
    v_mul_f32 v164, v164, v100
    v_mul_f32 v165, v165, v101
    v_mul_f32 v166, v166, v102
    v_mul_f32 v167, v167, v103
    v_cvt_pk_bf16_f32 v122, v164, v165
    v_cvt_pk_bf16_f32 v123, v166, v167
    v_fma_f32 v180, v36, v76, v180
    v_fma_f32 v181, v36, v77, v181
    v_fma_f32 v182, v36, v78, v182
    v_fma_f32 v183, v36, v79, v183
    v_fma_f32 v228, v36, v88, v228
    v_fma_f32 v229, v36, v89, v229
    v_fma_f32 v230, v36, v90, v230
    v_fma_f32 v231, v36, v91, v231
    v_mul_f32 v100, v180, v180
    v_mul_f32 v101, v181, v181
    v_mul_f32 v102, v182, v182
    v_mul_f32 v103, v183, v183
    v_fma_f32 v100, v100, v38, v37
    v_fma_f32 v101, v101, v38, v37
    v_fma_f32 v102, v102, v38, v37
    v_fma_f32 v103, v103, v38, v37
    v_mul_f32 v100, v100, v180
    v_mul_f32 v101, v101, v181
    v_mul_f32 v102, v102, v182
    v_mul_f32 v103, v103, v183
    v_exp_f32 v100, v100
    v_exp_f32 v101, v101
    v_exp_f32 v102, v102
    v_exp_f32 v103, v103
    v_mul_f32 v180, v180, v228
    v_mul_f32 v181, v181, v229
    v_mul_f32 v182, v182, v230
    v_mul_f32 v183, v183, v231
    v_fma_f32 v100, v100, v39, v39
    v_fma_f32 v101, v101, v39, v39
    v_fma_f32 v102, v102, v39, v39
    v_fma_f32 v103, v103, v39, v39
    v_rcp_f32 v100, v100
    v_rcp_f32 v101, v101
    v_rcp_f32 v102, v102
    v_rcp_f32 v103, v103
    s_nop 0
    v_mul_f32 v180, v180, v100
    v_mul_f32 v181, v181, v101
    v_mul_f32 v182, v182, v102
    v_mul_f32 v183, v183, v103
    v_cvt_pk_bf16_f32 v124, v180, v181
    v_cvt_pk_bf16_f32 v125, v182, v183
    buffer_store_dwordx4 v[120:123], v14, s[20:23], s55 offen offset:2048 sc1
    buffer_store_dwordx2 v[124:125], v14, s[20:23], s56 offen offset:2048 sc1
    v_fma_f32 v152, v40, v68, v152
    v_fma_f32 v153, v40, v69, v153
    v_fma_f32 v154, v40, v70, v154
    v_fma_f32 v155, v40, v71, v155
    v_fma_f32 v200, v40, v80, v200
    v_fma_f32 v201, v40, v81, v201
    v_fma_f32 v202, v40, v82, v202
    v_fma_f32 v203, v40, v83, v203
    v_mul_f32 v100, v152, v152
    v_mul_f32 v101, v153, v153
    v_mul_f32 v102, v154, v154
    v_mul_f32 v103, v155, v155
    v_fma_f32 v100, v100, v42, v41
    v_fma_f32 v101, v101, v42, v41
    v_fma_f32 v102, v102, v42, v41
    v_fma_f32 v103, v103, v42, v41
    v_mul_f32 v100, v100, v152
    v_mul_f32 v101, v101, v153
    v_mul_f32 v102, v102, v154
    v_mul_f32 v103, v103, v155
    v_exp_f32 v100, v100
    v_exp_f32 v101, v101
    v_exp_f32 v102, v102
    v_exp_f32 v103, v103
    v_mul_f32 v152, v152, v200
    v_mul_f32 v153, v153, v201
    v_mul_f32 v154, v154, v202
    v_mul_f32 v155, v155, v203
    v_fma_f32 v100, v100, v43, v43
    v_fma_f32 v101, v101, v43, v43
    v_fma_f32 v102, v102, v43, v43
    v_fma_f32 v103, v103, v43, v43
    v_rcp_f32 v100, v100
    v_rcp_f32 v101, v101
    v_rcp_f32 v102, v102
    v_rcp_f32 v103, v103
    s_nop 0
    v_mul_f32 v152, v152, v100
    v_mul_f32 v153, v153, v101
    v_mul_f32 v154, v154, v102
    v_mul_f32 v155, v155, v103
    v_cvt_pk_bf16_f32 v128, v152, v153
    v_cvt_pk_bf16_f32 v129, v154, v155
    v_fma_f32 v168, v40, v72, v168
    v_fma_f32 v169, v40, v73, v169
    v_fma_f32 v170, v40, v74, v170
    v_fma_f32 v171, v40, v75, v171
    v_fma_f32 v216, v40, v84, v216
    v_fma_f32 v217, v40, v85, v217
    v_fma_f32 v218, v40, v86, v218
    v_fma_f32 v219, v40, v87, v219
    v_mul_f32 v100, v168, v168
    v_mul_f32 v101, v169, v169
    v_mul_f32 v102, v170, v170
    v_mul_f32 v103, v171, v171
    v_fma_f32 v100, v100, v42, v41
    v_fma_f32 v101, v101, v42, v41
    v_fma_f32 v102, v102, v42, v41
    v_fma_f32 v103, v103, v42, v41
    v_mul_f32 v100, v100, v168
    v_mul_f32 v101, v101, v169
    v_mul_f32 v102, v102, v170
    v_mul_f32 v103, v103, v171
    v_exp_f32 v100, v100
    v_exp_f32 v101, v101
    v_exp_f32 v102, v102
    v_exp_f32 v103, v103
    v_mul_f32 v168, v168, v216
    v_mul_f32 v169, v169, v217
    v_mul_f32 v170, v170, v218
    v_mul_f32 v171, v171, v219
    v_fma_f32 v100, v100, v43, v43
    v_fma_f32 v101, v101, v43, v43
    v_fma_f32 v102, v102, v43, v43
    v_fma_f32 v103, v103, v43, v43
    v_rcp_f32 v100, v100
    v_rcp_f32 v101, v101
    v_rcp_f32 v102, v102
    v_rcp_f32 v103, v103
    s_nop 0
    v_mul_f32 v168, v168, v100
    v_mul_f32 v169, v169, v101
    v_mul_f32 v170, v170, v102
    v_mul_f32 v171, v171, v103
    v_cvt_pk_bf16_f32 v130, v168, v169
    v_cvt_pk_bf16_f32 v131, v170, v171
    v_fma_f32 v184, v40, v76, v184
    v_fma_f32 v185, v40, v77, v185
    v_fma_f32 v186, v40, v78, v186
    v_fma_f32 v187, v40, v79, v187
    v_fma_f32 v232, v40, v88, v232
    v_fma_f32 v233, v40, v89, v233
    v_fma_f32 v234, v40, v90, v234
    v_fma_f32 v235, v40, v91, v235
    v_mul_f32 v100, v184, v184
    v_mul_f32 v101, v185, v185
    v_mul_f32 v102, v186, v186
    v_mul_f32 v103, v187, v187
    v_fma_f32 v100, v100, v42, v41
    v_fma_f32 v101, v101, v42, v41
    v_fma_f32 v102, v102, v42, v41
    v_fma_f32 v103, v103, v42, v41
    v_mul_f32 v100, v100, v184
    v_mul_f32 v101, v101, v185
    v_mul_f32 v102, v102, v186
    v_mul_f32 v103, v103, v187
    v_exp_f32 v100, v100
    v_exp_f32 v101, v101
    v_exp_f32 v102, v102
    v_exp_f32 v103, v103
    v_mul_f32 v184, v184, v232
    v_mul_f32 v185, v185, v233
    v_mul_f32 v186, v186, v234
    v_mul_f32 v187, v187, v235
    v_fma_f32 v100, v100, v43, v43
    v_fma_f32 v101, v101, v43, v43
    v_fma_f32 v102, v102, v43, v43
    v_fma_f32 v103, v103, v43, v43
    v_rcp_f32 v100, v100
    v_rcp_f32 v101, v101
    v_rcp_f32 v102, v102
    v_rcp_f32 v103, v103
    s_nop 0
    v_mul_f32 v184, v184, v100
    v_mul_f32 v185, v185, v101
    v_mul_f32 v186, v186, v102
    v_mul_f32 v187, v187, v103
    v_cvt_pk_bf16_f32 v132, v184, v185
    v_cvt_pk_bf16_f32 v133, v186, v187
    buffer_store_dwordx4 v[128:131], v14, s[20:23], s55 offen offset:3072 sc1
    buffer_store_dwordx2 v[132:133], v14, s[20:23], s56 offen offset:3072 sc1
    s_endpgm
K1_qkv:
    s_sub_u32 s35, s35, s59
    s_cmp_ge_u32 s35, 6
    s_cselect_b32 s37, 1, 0
    s_cselect_b32 s51, 6, 0
    s_sub_u32 s36, s35, s51
    s_mul_i32 s51, s52, 6
    s_add_u32 s36, s36, s51
    s_lshl_b32 s51, s53, 1
    s_add_u32 s37, s37, s51
    s_mov_b32 s12, s6
    s_and_b32 s13, s7, 0xffff
    s_mov_b32 s14, 2457600
    s_mov_b32 s15, 0x00020000
    s_mov_b32 s16, s6
    s_and_b32 s17, s7, 0xffff
    s_mov_b32 s18, 2457600
    s_mov_b32 s19, 0x00020000
    s_mov_b32 s50, 122880
    s_mul_i32 s58, s36, 178
    s_sub_u32 s58, s58, 14
    s_lshl_b32 s55, s38, 4
    s_add_u32 s51, s58, s55
    v_add_u32 v19, s51, v14
    v_mul_i32_i24 v20, 1280, v19
    v_add_u32 v20, v20, v15
    v_cmp_gt_i32 vcc, 0, v19
    v_mov_b32 v21, s54
    s_nop 0
    v_cndmask_b32 v1, v20, v21, vcc
    s_add_u32 s51, s51, 128
    v_add_u32 v19, s51, v14
    v_mul_i32_i24 v20, 1280, v19
    v_add_u32 v20, v20, v15
    v_cmp_gt_i32 vcc, 0, v19
    v_mov_b32 v21, s54
    s_nop 0
    v_cndmask_b32 v2, v20, v21, vcc
    s_lshl_b32 s46, s38, 10
    s_add_u32 s47, s46, 8192
    s_cmp_ge_u32 s38, 4
    s_cselect_b32 s47, 28672, s47
    s_cselect_b32 s55, s54, 0
    v_or_b32 v2, s55, v2
    s_add_u32 s51, s38, 0
    s_and_b32 s55, s51, 14
    v_lshrrev_b32 v19, 1, v16
    v_add_u32 v19, s55, v19
    v_mul_u32_u24 v20, 13, v19
    v_lshrrev_b32 v20, 6, v20
    v_mul_u32_u24 v21, 5, v20
    v_sub_u32 v21, v19, v21
    v_lshlrev_b32 v21, 5, v21
    v_mul_u32_u24 v22, 1280, v20
    v_add_u32 v21, v21, v22
    v_and_b32 v22, 1, v16
    v_lshlrev_b32 v22, 4, v22
    s_mul_i32 s56, s37, 160
    v_add3_u32 v21, v21, v22, s56
    s_and_b32 s56, s51, 1
    s_lshl_b32 s56, s56, 4
    v_add_u32 v22, s56, v14
    v_mul_u32_u24 v22, 3840, v22
    v_add_u32 v21, v21, v22
    v_cmp_eq_u32 vcc, 15, v19
    v_mov_b32 v22, s54
    s_nop 0
    v_cndmask_b32 v3, v21, v22, vcc
    s_lshl_b32 s48, s51, 10
    s_add_u32 s48, s48, 12288
    s_add_u32 s51, s38, 8
    s_and_b32 s55, s51, 14
    v_lshrrev_b32 v19, 1, v16
    v_add_u32 v19, s55, v19
    v_mul_u32_u24 v20, 13, v19
    v_lshrrev_b32 v20, 6, v20
    v_mul_u32_u24 v21, 5, v20
    v_sub_u32 v21, v19, v21
    v_lshlrev_b32 v21, 5, v21
    v_mul_u32_u24 v22, 1280, v20
    v_add_u32 v21, v21, v22
    v_and_b32 v22, 1, v16
    v_lshlrev_b32 v22, 4, v22
    s_mul_i32 s56, s37, 160
    v_add3_u32 v21, v21, v22, s56
    s_and_b32 s56, s51, 1
    s_lshl_b32 s56, s56, 4
    v_add_u32 v22, s56, v14
    v_mul_u32_u24 v22, 3840, v22
    v_add_u32 v21, v21, v22
    v_cmp_eq_u32 vcc, 15, v19
    v_mov_b32 v22, s54
    s_nop 0
    v_cndmask_b32 v4, v21, v22, vcc
    s_lshl_b32 s49, s51, 10
    s_add_u32 s49, s49, 12288
    s_mul_i32 s51, s39, 3072
    v_lshlrev_b32 v19, 6, v18
    v_lshrrev_b32 v20, 2, v18
    v_sub_u32 v21, 4, v20
    v_and_b32 v21, 3, v21
    v_xor_b32 v21, v21, v17
    v_lshlrev_b32 v21, 4, v21
    v_add3_u32 v5, v19, v21, s51
    v_lshl_add_u32 v19, v17, 3, v20
    v_lshlrev_b32 v19, 6, v19
    v_and_b32 v21, 3, v18
    v_lshlrev_b32 v21, 3, v21
    v_add_u32 v22, v19, v21
    v_add_u32 v22, 12288, v22
    v_and_b32 v23, 1, v17
    v_lshlrev_b32 v23, 5, v23
    v_xor_b32 v21, 32, v23
    s_lshl_b32 s51, s40, 13
    v_add3_u32 v6, v22, v23, s51
    v_add3_u32 v7, v22, v21, s51
    s_lshl_b32 s51, s39, 11
    v_add_u32 v253, s51, v6
    v_add_u32 v254, s51, v7
    s_mov_b32 s41, 0
    s_mov_b32 s61, 0
    s_lshl_b32 s43, s60, 6
    s_mul_i32 s44, s60, s50
    v_mov_b32 v16, v139
    s_add_u32 m0, s41, s46
    s_nop 0
    buffer_load_dwordx4 v1, s[8:11], s43 offen lds
    s_add_u32 m0, s41, s47
    s_nop 0
    buffer_load_dwordx4 v2, s[8:11], s43 offen lds
    s_add_u32 m0, s41, s48
    s_nop 0
    buffer_load_dwordx4 v3, s[12:15], s44 offen lds
    s_add_u32 m0, s41, s49
    s_nop 0
    buffer_load_dwordx4 v4, s[16:19], s44 offen lds
    s_add_u32 s41, s41, 29696
    s_cmp_eq_u32 s41, 148480
    s_cselect_b32 s41, 0, s41
    s_add_u32 s43, s43, 64
    s_add_u32 s44, s44, s50
    s_cmp_eq_u32 s43, 1280
    s_cselect_b32 s43, 0, s43
    s_cselect_b32 s44, 0, s44
    s_add_u32 s61, s61, 1
    s_cmp_ge_u32 s61, 20
    s_cselect_b32 s43, s54, s43
    s_cselect_b32 s44, s54, s44
    s_add_u32 m0, s41, s46
    s_nop 0
    buffer_load_dwordx4 v1, s[8:11], s43 offen lds
    s_add_u32 m0, s41, s47
    s_nop 0
    buffer_load_dwordx4 v2, s[8:11], s43 offen lds
    s_add_u32 m0, s41, s48
    s_nop 0
    buffer_load_dwordx4 v3, s[12:15], s44 offen lds
    s_add_u32 m0, s41, s49
    s_nop 0
    buffer_load_dwordx4 v4, s[16:19], s44 offen lds
    s_add_u32 s41, s41, 29696
    s_cmp_eq_u32 s41, 148480
    s_cselect_b32 s41, 0, s41
    s_add_u32 s43, s43, 64
    s_add_u32 s44, s44, s50
    s_cmp_eq_u32 s43, 1280
    s_cselect_b32 s43, 0, s43
    s_cselect_b32 s44, 0, s44
    s_add_u32 s61, s61, 1
    s_cmp_ge_u32 s61, 20
    s_cselect_b32 s43, s54, s43
    s_cselect_b32 s44, s54, s44
    s_add_u32 m0, s41, s46
    s_nop 0
    buffer_load_dwordx4 v1, s[8:11], s43 offen lds
    s_add_u32 m0, s41, s47
    s_nop 0
    buffer_load_dwordx4 v2, s[8:11], s43 offen lds
    s_add_u32 m0, s41, s48
    s_nop 0
    buffer_load_dwordx4 v3, s[12:15], s44 offen lds
    s_add_u32 m0, s41, s49
    s_nop 0
    buffer_load_dwordx4 v4, s[16:19], s44 offen lds
    s_add_u32 s41, s41, 29696
    s_cmp_eq_u32 s41, 148480
    s_cselect_b32 s41, 0, s41
    s_add_u32 s43, s43, 64
    s_add_u32 s44, s44, s50
    s_cmp_eq_u32 s43, 1280
    s_cselect_b32 s43, 0, s43
    s_cselect_b32 s44, 0, s44
    s_add_u32 s61, s61, 1
    s_cmp_ge_u32 s61, 20
    s_cselect_b32 s43, s54, s43
    s_cselect_b32 s44, s54, s44
    s_mul_i32 s51, s39, 48
    v_add_u32 v14, s51, v18
    v_mul_u32_u24 v15, 48, v14
    v_mul_u32_u24 v23, 80, v14
    v_add_u32 v23, 73728, v23
    v_lshlrev_b32 v19, 2, v17
    v_add_u32 v19, 0, v19
    v_mul_u32_u24 v20, 13, v19
    v_lshrrev_b32 v20, 8, v20
    v_mul_u32_u24 v21, 20, v20
    v_sub_u32 v21, v19, v21
    v_mul_u32_u24 v22, 9216, v20
    v_lshl_add_u32 v22, v21, 1, v22
    v_add_u32 v236, v22, v15
    v_mul_u32_u24 v22, 15520, v20
    v_lshl_add_u32 v22, v21, 2, v22
    v_add_u32 v241, v22, v23
    v_lshlrev_b32 v19, 2, v17
    v_add_u32 v19, 16, v19
    v_mul_u32_u24 v20, 13, v19
    v_lshrrev_b32 v20, 8, v20
    v_mul_u32_u24 v21, 20, v20
    v_sub_u32 v21, v19, v21
    v_mul_u32_u24 v22, 9216, v20
    v_lshl_add_u32 v22, v21, 1, v22
    v_add_u32 v237, v22, v15
    v_mul_u32_u24 v22, 15520, v20
    v_lshl_add_u32 v22, v21, 2, v22
    v_add_u32 v242, v22, v23
    v_lshlrev_b32 v19, 2, v17
    v_add_u32 v19, 32, v19
    v_mul_u32_u24 v20, 13, v19
    v_lshrrev_b32 v20, 8, v20
    v_mul_u32_u24 v21, 20, v20
    v_sub_u32 v21, v19, v21
    v_mul_u32_u24 v22, 9216, v20
    v_lshl_add_u32 v22, v21, 1, v22
    v_add_u32 v238, v22, v15
    v_mul_u32_u24 v22, 15520, v20
    v_lshl_add_u32 v22, v21, 2, v22
    v_add_u32 v243, v22, v23
    v_lshlrev_b32 v19, 2, v17
    v_add_u32 v19, 48, v19
    v_mul_u32_u24 v20, 13, v19
    v_lshrrev_b32 v20, 8, v20
    v_mul_u32_u24 v21, 20, v20
    v_sub_u32 v21, v19, v21
    v_mul_u32_u24 v22, 9216, v20
    v_lshl_add_u32 v22, v21, 1, v22
    v_add_u32 v239, v22, v15
    v_mul_u32_u24 v22, 15520, v20
    v_lshl_add_u32 v22, v21, 2, v22
    v_add_u32 v252, v22, v23
    v_lshlrev_b32 v19, 2, v17
    v_add_u32 v19, 64, v19
    v_mul_u32_u24 v20, 13, v19
    v_lshrrev_b32 v20, 8, v20
    v_mul_u32_u24 v21, 20, v20
    v_sub_u32 v21, v19, v21
    v_mul_u32_u24 v22, 9216, v20
    v_lshl_add_u32 v22, v21, 1, v22
    v_add_u32 v240, v22, v15
    v_mul_u32_u24 v22, 15520, v20
    v_lshl_add_u32 v22, v21, 2, v22
    v_add_u32 v13, v22, v23
    s_add_u32 s28, s32, 12730368
    s_addc_u32 s29, s33, 0
    s_and_b32 s29, s29, 0xffff
    s_mov_b32 s30, 65536
    s_mov_b32 s31, 0x00020000
    s_mul_i32 s51, s39, 48
    s_add_u32 s51, s51, s58
    v_add_u32 v23, s51, v18
    v_mov_b32 v22, s54
    v_mov_b32 v17, 0
    v_lshlrev_b32 v18, 5, v23
    v_add_u32 v18, 16, v18
    v_cmp_gt_i32 vcc, 0, v23
    v_add_u32 v23, 16, v23
    s_nop 0
    v_cndmask_b32 v18, v18, v22, vcc
    v_lshlrev_b32 v19, 5, v23
    v_add_u32 v19, 16, v19
    v_cmp_gt_i32 vcc, 0, v23
    v_add_u32 v23, 16, v23
    s_nop 0
    v_cndmask_b32 v19, v19, v22, vcc
    v_lshlrev_b32 v20, 5, v23
    v_add_u32 v20, 16, v20
    v_cmp_gt_i32 vcc, 0, v23
    v_add_u32 v23, 16, v23
    s_nop 0
    v_cndmask_b32 v20, v20, v22, vcc
    v_mov_b32 v24, 0x3f803f80
    v_mov_b32 v25, 0x3f803f80
    v_mov_b32 v26, 0x3f803f80
    v_mov_b32 v27, 0x3f803f80
    v_mov_b32 v28, 0
    v_mov_b32 v29, 0
    v_mov_b32 v30, 0
    v_mov_b32 v31, 0
    v_mov_b32 v32, 0
    v_mov_b32 v33, 0
    v_mov_b32 v34, 0
    v_mov_b32 v35, 0
    v_mov_b32 v36, 0
    v_mov_b32 v37, 0
    v_mov_b32 v38, 0
    v_mov_b32 v39, 0
    v_mov_b32 v40, 0
    v_mov_b32 v41, 0
    v_mov_b32 v42, 0
    v_mov_b32 v43, 0
    v_mov_b32 v44, 0
    v_mov_b32 v45, 0
    v_mov_b32 v46, 0
    v_mov_b32 v47, 0
    v_mov_b32 v48, 0
    v_mov_b32 v49, 0
    v_mov_b32 v50, 0
    v_mov_b32 v51, 0
    v_mov_b32 v140, 0
    v_mov_b32 v141, 0
    v_mov_b32 v142, 0
    v_mov_b32 v143, 0
    v_mov_b32 v144, 0
    v_mov_b32 v145, 0
    v_mov_b32 v146, 0
    v_mov_b32 v147, 0
    v_mov_b32 v148, 0
    v_mov_b32 v149, 0
    v_mov_b32 v150, 0
    v_mov_b32 v151, 0
    v_mov_b32 v152, 0
    v_mov_b32 v153, 0
    v_mov_b32 v154, 0
    v_mov_b32 v155, 0
    v_mov_b32 v156, 0
    v_mov_b32 v157, 0
    v_mov_b32 v158, 0
    v_mov_b32 v159, 0
    v_mov_b32 v160, 0
    v_mov_b32 v161, 0
    v_mov_b32 v162, 0
    v_mov_b32 v163, 0
    v_mov_b32 v164, 0
    v_mov_b32 v165, 0
    v_mov_b32 v166, 0
    v_mov_b32 v167, 0
    v_mov_b32 v168, 0
    v_mov_b32 v169, 0
    v_mov_b32 v170, 0
    v_mov_b32 v171, 0
    v_mov_b32 v172, 0
    v_mov_b32 v173, 0
    v_mov_b32 v174, 0
    v_mov_b32 v175, 0
    v_mov_b32 v176, 0
    v_mov_b32 v177, 0
    v_mov_b32 v178, 0
    v_mov_b32 v179, 0
    v_mov_b32 v180, 0
    v_mov_b32 v181, 0
    v_mov_b32 v182, 0
    v_mov_b32 v183, 0
    v_mov_b32 v184, 0
    v_mov_b32 v185, 0
    v_mov_b32 v186, 0
    v_mov_b32 v187, 0
    v_mov_b32 v188, 0
    v_mov_b32 v189, 0
    v_mov_b32 v190, 0
    v_mov_b32 v191, 0
    v_mov_b32 v192, 0
    v_mov_b32 v193, 0
    v_mov_b32 v194, 0
    v_mov_b32 v195, 0
    v_mov_b32 v196, 0
    v_mov_b32 v197, 0
    v_mov_b32 v198, 0
    v_mov_b32 v199, 0
    v_mov_b32 v200, 0
    v_mov_b32 v201, 0
    v_mov_b32 v202, 0
    v_mov_b32 v203, 0
    v_mov_b32 v204, 0
    v_mov_b32 v205, 0
    v_mov_b32 v206, 0
    v_mov_b32 v207, 0
    v_mov_b32 v208, 0
    v_mov_b32 v209, 0
    v_mov_b32 v210, 0
    v_mov_b32 v211, 0
    v_mov_b32 v212, 0
    v_mov_b32 v213, 0
    v_mov_b32 v214, 0
    v_mov_b32 v215, 0
    v_mov_b32 v216, 0
    v_mov_b32 v217, 0
    v_mov_b32 v218, 0
    v_mov_b32 v219, 0
    v_mov_b32 v220, 0
    v_mov_b32 v221, 0
    v_mov_b32 v222, 0
    v_mov_b32 v223, 0
    v_mov_b32 v224, 0
    v_mov_b32 v225, 0
    v_mov_b32 v226, 0
    v_mov_b32 v227, 0
    v_mov_b32 v228, 0
    v_mov_b32 v229, 0
    v_mov_b32 v230, 0
    v_mov_b32 v231, 0
    v_mov_b32 v232, 0
    v_mov_b32 v233, 0
    v_mov_b32 v234, 0
    v_mov_b32 v235, 0
    s_mov_b32 s42, 0
    s_mov_b32 s45, 0
    s_waitcnt vmcnt(8)
    s_barrier
    s_cmp_eq_u32 s40, 1
    s_cbranch_scc1 Q1_entry
    v_add_u32 v9, s42, v5
    v_add_u32 v10, s42, v6
    v_add_u32 v11, s42, v7
    v_add_u32 v255, s42, v253
    v_add_u32 v14, s42, v254
    ds_read_b64_tr_b16 v[244:245], v255 offset:0
    ds_read_b64_tr_b16 v[246:247], v255 offset:256
    ds_read_b64_tr_b16 v[248:249], v14 offset:0
    ds_read_b64_tr_b16 v[250:251], v14 offset:256
    ds_read_b128 v[52:55], v9 offset:0
    ds_read_b128 v[56:59], v9 offset:1024
    ds_read_b128 v[60:63], v9 offset:2048
    ds_read_b64_tr_b16 v[64:65], v10 offset:0
    ds_read_b64_tr_b16 v[66:67], v10 offset:256
    ds_read_b64_tr_b16 v[68:69], v11 offset:0
    ds_read_b64_tr_b16 v[70:71], v11 offset:256
    ds_read_b64_tr_b16 v[72:73], v10 offset:2048
    ds_read_b64_tr_b16 v[74:75], v10 offset:2304
    ds_read_b64_tr_b16 v[76:77], v11 offset:2048
    ds_read_b64_tr_b16 v[78:79], v11 offset:2304
    ds_read_b64_tr_b16 v[80:81], v10 offset:4096
    ds_read_b64_tr_b16 v[82:83], v10 offset:4352
    ds_read_b64_tr_b16 v[84:85], v11 offset:4096
    ds_read_b64_tr_b16 v[86:87], v11 offset:4352
    ds_read_b64_tr_b16 v[88:89], v10 offset:6144
    ds_read_b64_tr_b16 v[90:91], v10 offset:6400
    ds_read_b64_tr_b16 v[92:93], v11 offset:6144
    ds_read_b64_tr_b16 v[94:95], v11 offset:6400
    s_mov_b32 s42, 29696
    v_add_u32 v9, s42, v5
    v_add_u32 v10, s42, v6
    v_add_u32 v11, s42, v7
    v_add_u32 v255, s42, v253
    v_add_u32 v14, s42, v254
    s_waitcnt lgkmcnt(15)
    v_mfma_f32_16x16x32_bf16 v[44:47], v[244:247], v[24:27], v[44:47]
    v_mfma_f32_16x16x32_bf16 v[48:51], v[248:251], v[24:27], v[48:51]
    s_add_u32 s42, s42, 29696
    s_waitcnt vmcnt(4) lgkmcnt(0)
    s_barrier
    v_mfma_f32_16x16x32_bf16 v[140:143], v[64:67], v[52:55], v[140:143]
    buffer_load_dword v15, v16, s[80:83], s84 offen
    s_add_u32 s84, s84, s85
    s_add_u32 s87, s87, 1
    s_cmp_eq_u32 s87, 10
    s_cselect_b32 s84, s88, s84
    s_cselect_b32 s87, 0, s87
    buffer_load_dword v15, v16, s[80:83], s84 offen
    s_add_u32 s84, s84, s85
    s_add_u32 s87, s87, 1
    s_cmp_eq_u32 s87, 10
    s_cselect_b32 s84, s88, s84
    s_cselect_b32 s87, 0, s87
    ds_read_b64_tr_b16 v[244:245], v255 offset:0
    ds_read_b64_tr_b16 v[246:247], v255 offset:256
    s_add_u32 m0, s41, s46
    v_mfma_f32_16x16x32_bf16 v[144:147], v[64:67], v[56:59], v[144:147]
    buffer_load_dwordx4 v1, s[8:11], s43 offen lds
    ds_read_b64_tr_b16 v[248:249], v14 offset:0
    v_mfma_f32_16x16x32_bf16 v[148:151], v[64:67], v[60:63], v[148:151]
    ds_read_b64_tr_b16 v[250:251], v14 offset:256
    s_add_u32 m0, s41, s47
    v_mfma_f32_16x16x32_bf16 v[152:155], v[68:71], v[52:55], v[152:155]
    buffer_load_dwordx4 v2, s[8:11], s43 offen lds
    ds_read_b128 v[96:99], v9 offset:0
    v_mfma_f32_16x16x32_bf16 v[156:159], v[68:71], v[56:59], v[156:159]
    ds_read_b128 v[100:103], v9 offset:1024
    s_add_u32 m0, s41, s48
    v_mfma_f32_16x16x32_bf16 v[160:163], v[68:71], v[60:63], v[160:163]
    buffer_load_dwordx4 v3, s[12:15], s44 offen lds
    ds_read_b128 v[104:107], v9 offset:2048
    v_mfma_f32_16x16x32_bf16 v[164:167], v[72:75], v[52:55], v[164:167]
    ds_read_b64_tr_b16 v[108:109], v10 offset:0
    s_add_u32 m0, s41, s49
    v_mfma_f32_16x16x32_bf16 v[168:171], v[72:75], v[56:59], v[168:171]
    buffer_load_dwordx4 v4, s[16:19], s44 offen lds
    ds_read_b64_tr_b16 v[110:111], v10 offset:256
    v_mfma_f32_16x16x32_bf16 v[172:175], v[72:75], v[60:63], v[172:175]
    ds_read_b64_tr_b16 v[112:113], v11 offset:0
    s_add_u32 s41, s41, 29696
    s_cmp_eq_u32 s41, 148480
    s_cselect_b32 s41, 0, s41
    v_mfma_f32_16x16x32_bf16 v[176:179], v[76:79], v[52:55], v[176:179]
    ds_read_b64_tr_b16 v[114:115], v11 offset:256
    s_add_u32 s43, s43, 64
    s_add_u32 s44, s44, s50
    s_cmp_eq_u32 s43, 1280
    s_cselect_b32 s43, 0, s43
    s_cselect_b32 s44, 0, s44
    v_mfma_f32_16x16x32_bf16 v[180:183], v[76:79], v[56:59], v[180:183]
    ds_read_b64_tr_b16 v[116:117], v10 offset:2048
    s_add_u32 s61, s61, 1
    s_cmp_ge_u32 s61, 20
    s_cselect_b32 s43, s54, s43
    s_cselect_b32 s44, s54, s44
    v_mfma_f32_16x16x32_bf16 v[184:187], v[76:79], v[60:63], v[184:187]
    ds_read_b64_tr_b16 v[118:119], v10 offset:2304
    s_add_u32 m0, s41, s46
    v_mfma_f32_16x16x32_bf16 v[188:191], v[80:83], v[52:55], v[188:191]
    buffer_load_dwordx4 v1, s[8:11], s43 offen lds
    ds_read_b64_tr_b16 v[120:121], v11 offset:2048
    v_mfma_f32_16x16x32_bf16 v[192:195], v[80:83], v[56:59], v[192:195]
    ds_read_b64_tr_b16 v[122:123], v11 offset:2304
    s_add_u32 m0, s41, s47
    v_mfma_f32_16x16x32_bf16 v[196:199], v[80:83], v[60:63], v[196:199]
    buffer_load_dwordx4 v2, s[8:11], s43 offen lds
    ds_read_b64_tr_b16 v[124:125], v10 offset:4096
    v_mfma_f32_16x16x32_bf16 v[200:203], v[84:87], v[52:55], v[200:203]
    ds_read_b64_tr_b16 v[126:127], v10 offset:4352
    s_add_u32 m0, s41, s48
    v_mfma_f32_16x16x32_bf16 v[204:207], v[84:87], v[56:59], v[204:207]
    buffer_load_dwordx4 v3, s[12:15], s44 offen lds
    ds_read_b64_tr_b16 v[128:129], v11 offset:4096
    v_mfma_f32_16x16x32_bf16 v[208:211], v[84:87], v[60:63], v[208:211]
    ds_read_b64_tr_b16 v[130:131], v11 offset:4352
    s_add_u32 m0, s41, s49
    v_mfma_f32_16x16x32_bf16 v[212:215], v[88:91], v[52:55], v[212:215]
    buffer_load_dwordx4 v4, s[16:19], s44 offen lds
    ds_read_b64_tr_b16 v[132:133], v10 offset:6144
    v_mfma_f32_16x16x32_bf16 v[216:219], v[88:91], v[56:59], v[216:219]
    ds_read_b64_tr_b16 v[134:135], v10 offset:6400
    s_add_u32 s41, s41, 29696
    s_cmp_eq_u32 s41, 148480
    s_cselect_b32 s41, 0, s41
    v_mfma_f32_16x16x32_bf16 v[220:223], v[88:91], v[60:63], v[220:223]
    ds_read_b64_tr_b16 v[136:137], v11 offset:6144
    s_add_u32 s43, s43, 64
    s_add_u32 s44, s44, s50
    s_cmp_eq_u32 s43, 1280
    s_cselect_b32 s43, 0, s43
    s_cselect_b32 s44, 0, s44
    v_mfma_f32_16x16x32_bf16 v[224:227], v[92:95], v[52:55], v[224:227]
    ds_read_b64_tr_b16 v[138:139], v11 offset:6400
    s_add_u32 s61, s61, 1
    s_cmp_ge_u32 s61, 20
    s_cselect_b32 s43, s54, s43
    s_cselect_b32 s44, s54, s44
    v_mfma_f32_16x16x32_bf16 v[228:231], v[92:95], v[56:59], v[228:231]
    v_add_u32 v9, s42, v5
    v_add_u32 v10, s42, v6
    v_mfma_f32_16x16x32_bf16 v[232:235], v[92:95], v[60:63], v[232:235]
    v_add_u32 v11, s42, v7
    v_add_u32 v255, s42, v253
    s_waitcnt lgkmcnt(15)
    v_mfma_f32_16x16x32_bf16 v[44:47], v[244:247], v[24:27], v[44:47]
    v_add_u32 v14, s42, v254
    v_mfma_f32_16x16x32_bf16 v[48:51], v[248:251], v[24:27], v[48:51]
    s_add_u32 s42, s42, 29696
    s_cmp_eq_u32 s42, 148480
    s_cselect_b32 s42, 0, s42
    s_add_u32 s45, s45, 1
    s_waitcnt vmcnt(10) lgkmcnt(0)
    s_barrier
    v_mfma_f32_16x16x32_bf16 v[140:143], v[108:111], v[96:99], v[140:143]
    buffer_load_dword v15, v16, s[80:83], s84 offen
    s_add_u32 s84, s84, s85
    s_add_u32 s87, s87, 1
    s_cmp_eq_u32 s87, 10
    s_cselect_b32 s84, s88, s84
    s_cselect_b32 s87, 0, s87
    ds_read_b64_tr_b16 v[244:245], v255 offset:0
    ds_read_b64_tr_b16 v[246:247], v255 offset:256
    s_add_u32 m0, s41, s46
    v_mfma_f32_16x16x32_bf16 v[144:147], v[108:111], v[100:103], v[144:147]
    buffer_load_dwordx4 v1, s[8:11], s43 offen lds
    ds_read_b64_tr_b16 v[248:249], v14 offset:0
    v_mfma_f32_16x16x32_bf16 v[148:151], v[108:111], v[104:107], v[148:151]
    ds_read_b64_tr_b16 v[250:251], v14 offset:256
    s_add_u32 m0, s41, s47
    v_mfma_f32_16x16x32_bf16 v[152:155], v[112:115], v[96:99], v[152:155]
    buffer_load_dwordx4 v2, s[8:11], s43 offen lds
    ds_read_b128 v[52:55], v9 offset:0
    v_mfma_f32_16x16x32_bf16 v[156:159], v[112:115], v[100:103], v[156:159]
    ds_read_b128 v[56:59], v9 offset:1024
    s_add_u32 m0, s41, s48
    v_mfma_f32_16x16x32_bf16 v[160:163], v[112:115], v[104:107], v[160:163]
    buffer_load_dwordx4 v3, s[12:15], s44 offen lds
    ds_read_b128 v[60:63], v9 offset:2048
    v_mfma_f32_16x16x32_bf16 v[164:167], v[116:119], v[96:99], v[164:167]
    ds_read_b64_tr_b16 v[64:65], v10 offset:0
    s_add_u32 m0, s41, s49
    v_mfma_f32_16x16x32_bf16 v[168:171], v[116:119], v[100:103], v[168:171]
    buffer_load_dwordx4 v4, s[16:19], s44 offen lds
    ds_read_b64_tr_b16 v[66:67], v10 offset:256
    v_mfma_f32_16x16x32_bf16 v[172:175], v[116:119], v[104:107], v[172:175]
    ds_read_b64_tr_b16 v[68:69], v11 offset:0
    s_add_u32 s41, s41, 29696
    s_cmp_eq_u32 s41, 148480
    s_cselect_b32 s41, 0, s41
    v_mfma_f32_16x16x32_bf16 v[176:179], v[120:123], v[96:99], v[176:179]
    ds_read_b64_tr_b16 v[70:71], v11 offset:256
    s_add_u32 s43, s43, 64
    s_add_u32 s44, s44, s50
    s_cmp_eq_u32 s43, 1280
    s_cselect_b32 s43, 0, s43
    s_cselect_b32 s44, 0, s44
    v_mfma_f32_16x16x32_bf16 v[180:183], v[120:123], v[100:103], v[180:183]
    ds_read_b64_tr_b16 v[72:73], v10 offset:2048
    s_add_u32 s61, s61, 1
    s_cmp_ge_u32 s61, 20
    s_cselect_b32 s43, s54, s43
    s_cselect_b32 s44, s54, s44
    v_mfma_f32_16x16x32_bf16 v[184:187], v[120:123], v[104:107], v[184:187]
    ds_read_b64_tr_b16 v[74:75], v10 offset:2304
    s_add_u32 m0, s41, s46
    v_mfma_f32_16x16x32_bf16 v[188:191], v[124:127], v[96:99], v[188:191]
    buffer_load_dwordx4 v1, s[8:11], s43 offen lds
    ds_read_b64_tr_b16 v[76:77], v11 offset:2048
    v_mfma_f32_16x16x32_bf16 v[192:195], v[124:127], v[100:103], v[192:195]
    ds_read_b64_tr_b16 v[78:79], v11 offset:2304
    s_add_u32 m0, s41, s47
    v_mfma_f32_16x16x32_bf16 v[196:199], v[124:127], v[104:107], v[196:199]
    buffer_load_dwordx4 v2, s[8:11], s43 offen lds
    ds_read_b64_tr_b16 v[80:81], v10 offset:4096
    v_mfma_f32_16x16x32_bf16 v[200:203], v[128:131], v[96:99], v[200:203]
    ds_read_b64_tr_b16 v[82:83], v10 offset:4352
    s_add_u32 m0, s41, s48
    v_mfma_f32_16x16x32_bf16 v[204:207], v[128:131], v[100:103], v[204:207]
    buffer_load_dwordx4 v3, s[12:15], s44 offen lds
    ds_read_b64_tr_b16 v[84:85], v11 offset:4096
    v_mfma_f32_16x16x32_bf16 v[208:211], v[128:131], v[104:107], v[208:211]
    ds_read_b64_tr_b16 v[86:87], v11 offset:4352
    s_add_u32 m0, s41, s49
    v_mfma_f32_16x16x32_bf16 v[212:215], v[132:135], v[96:99], v[212:215]
    buffer_load_dwordx4 v4, s[16:19], s44 offen lds
    ds_read_b64_tr_b16 v[88:89], v10 offset:6144
    v_mfma_f32_16x16x32_bf16 v[216:219], v[132:135], v[100:103], v[216:219]
    ds_read_b64_tr_b16 v[90:91], v10 offset:6400
    s_add_u32 s41, s41, 29696
    s_cmp_eq_u32 s41, 148480
    s_cselect_b32 s41, 0, s41
    v_mfma_f32_16x16x32_bf16 v[220:223], v[132:135], v[104:107], v[220:223]
    ds_read_b64_tr_b16 v[92:93], v11 offset:6144
    s_add_u32 s43, s43, 64
    s_add_u32 s44, s44, s50
    s_cmp_eq_u32 s43, 1280
    s_cselect_b32 s43, 0, s43
    s_cselect_b32 s44, 0, s44
    v_mfma_f32_16x16x32_bf16 v[224:227], v[136:139], v[96:99], v[224:227]
    ds_read_b64_tr_b16 v[94:95], v11 offset:6400
    s_add_u32 s61, s61, 1
    s_cmp_ge_u32 s61, 20
    s_cselect_b32 s43, s54, s43
    s_cselect_b32 s44, s54, s44
    v_mfma_f32_16x16x32_bf16 v[228:231], v[136:139], v[100:103], v[228:231]
    v_add_u32 v9, s42, v5
    v_add_u32 v10, s42, v6
    v_mfma_f32_16x16x32_bf16 v[232:235], v[136:139], v[104:107], v[232:235]
    v_add_u32 v11, s42, v7
    v_add_u32 v255, s42, v253
    s_waitcnt lgkmcnt(15)
    v_mfma_f32_16x16x32_bf16 v[44:47], v[244:247], v[24:27], v[44:47]
    v_add_u32 v14, s42, v254
    v_mfma_f32_16x16x32_bf16 v[48:51], v[248:251], v[24:27], v[48:51]
    s_add_u32 s42, s42, 29696
    s_cmp_eq_u32 s42, 148480
    s_cselect_b32 s42, 0, s42
    s_add_u32 s45, s45, 1
    .p2align 3
Q_loop:
    s_waitcnt vmcnt(13) lgkmcnt(0)
    s_barrier
    v_mfma_f32_16x16x32_bf16 v[140:143], v[64:67], v[52:55], v[140:143]
    buffer_load_dword v15, v16, s[80:83], s84 offen
    s_add_u32 s84, s84, s85
    s_add_u32 s87, s87, 1
    s_cmp_eq_u32 s87, 10
    s_cselect_b32 s84, s88, s84
    s_cselect_b32 s87, 0, s87
    ds_read_b64_tr_b16 v[244:245], v255 offset:0
    ds_read_b64_tr_b16 v[246:247], v255 offset:256
    s_add_u32 m0, s41, s46
    v_mfma_f32_16x16x32_bf16 v[144:147], v[64:67], v[56:59], v[144:147]
    buffer_load_dwordx4 v1, s[8:11], s43 offen lds
    ds_read_b64_tr_b16 v[248:249], v14 offset:0
    v_mfma_f32_16x16x32_bf16 v[148:151], v[64:67], v[60:63], v[148:151]
    ds_read_b64_tr_b16 v[250:251], v14 offset:256
    v_mfma_f32_16x16x32_bf16 v[152:155], v[68:71], v[52:55], v[152:155]
    ds_read_b128 v[96:99], v9 offset:0
    v_mfma_f32_16x16x32_bf16 v[156:159], v[68:71], v[56:59], v[156:159]
    ds_read_b128 v[100:103], v9 offset:1024
    v_mfma_f32_16x16x32_bf16 v[160:163], v[68:71], v[60:63], v[160:163]
    ds_read_b128 v[104:107], v9 offset:2048
    v_mfma_f32_16x16x32_bf16 v[164:167], v[72:75], v[52:55], v[164:167]
    ds_read_b64_tr_b16 v[108:109], v10 offset:0
    s_add_u32 m0, s41, s47
    v_mfma_f32_16x16x32_bf16 v[168:171], v[72:75], v[56:59], v[168:171]
    buffer_load_dwordx4 v2, s[8:11], s43 offen lds
    ds_read_b64_tr_b16 v[110:111], v10 offset:256
    v_mfma_f32_16x16x32_bf16 v[172:175], v[72:75], v[60:63], v[172:175]
    ds_read_b64_tr_b16 v[112:113], v11 offset:0
    v_mfma_f32_16x16x32_bf16 v[176:179], v[76:79], v[52:55], v[176:179]
    ds_read_b64_tr_b16 v[114:115], v11 offset:256
    v_mfma_f32_16x16x32_bf16 v[180:183], v[76:79], v[56:59], v[180:183]
    ds_read_b64_tr_b16 v[116:117], v10 offset:2048
    v_mfma_f32_16x16x32_bf16 v[184:187], v[76:79], v[60:63], v[184:187]
    ds_read_b64_tr_b16 v[118:119], v10 offset:2304
    v_mfma_f32_16x16x32_bf16 v[188:191], v[80:83], v[52:55], v[188:191]
    ds_read_b64_tr_b16 v[120:121], v11 offset:2048
    s_add_u32 m0, s41, s48
    v_mfma_f32_16x16x32_bf16 v[192:195], v[80:83], v[56:59], v[192:195]
    buffer_load_dwordx4 v3, s[12:15], s44 offen lds
    ds_read_b64_tr_b16 v[122:123], v11 offset:2304
    v_mfma_f32_16x16x32_bf16 v[196:199], v[80:83], v[60:63], v[196:199]
    ds_read_b64_tr_b16 v[124:125], v10 offset:4096
    v_mfma_f32_16x16x32_bf16 v[200:203], v[84:87], v[52:55], v[200:203]
    ds_read_b64_tr_b16 v[126:127], v10 offset:4352
    v_mfma_f32_16x16x32_bf16 v[204:207], v[84:87], v[56:59], v[204:207]
    ds_read_b64_tr_b16 v[128:129], v11 offset:4096
    v_mfma_f32_16x16x32_bf16 v[208:211], v[84:87], v[60:63], v[208:211]
    ds_read_b64_tr_b16 v[130:131], v11 offset:4352
    v_mfma_f32_16x16x32_bf16 v[212:215], v[88:91], v[52:55], v[212:215]
    ds_read_b64_tr_b16 v[132:133], v10 offset:6144
    s_add_u32 m0, s41, s49
    v_mfma_f32_16x16x32_bf16 v[216:219], v[88:91], v[56:59], v[216:219]
    buffer_load_dwordx4 v4, s[16:19], s44 offen lds
    ds_read_b64_tr_b16 v[134:135], v10 offset:6400
    v_mfma_f32_16x16x32_bf16 v[220:223], v[88:91], v[60:63], v[220:223]
    ds_read_b64_tr_b16 v[136:137], v11 offset:6144
    s_add_u32 s41, s41, 29696
    s_cmp_eq_u32 s41, 148480
    s_cselect_b32 s41, 0, s41
    v_mfma_f32_16x16x32_bf16 v[224:227], v[92:95], v[52:55], v[224:227]
    ds_read_b64_tr_b16 v[138:139], v11 offset:6400
    s_add_u32 s43, s43, 64
    s_add_u32 s44, s44, s50
    s_cmp_eq_u32 s43, 1280
    s_cselect_b32 s43, 0, s43
    s_cselect_b32 s44, 0, s44
    v_mfma_f32_16x16x32_bf16 v[228:231], v[92:95], v[56:59], v[228:231]
    s_add_u32 s61, s61, 1
    s_cmp_ge_u32 s61, 20
    s_cselect_b32 s43, s54, s43
    s_cselect_b32 s44, s54, s44
    v_mfma_f32_16x16x32_bf16 v[232:235], v[92:95], v[60:63], v[232:235]
    v_add_u32 v9, s42, v5
    v_add_u32 v10, s42, v6
    s_waitcnt lgkmcnt(15)
    v_mfma_f32_16x16x32_bf16 v[44:47], v[244:247], v[24:27], v[44:47]
    v_add_u32 v11, s42, v7
    v_add_u32 v255, s42, v253
    v_add_u32 v14, s42, v254
    v_mfma_f32_16x16x32_bf16 v[48:51], v[248:251], v[24:27], v[48:51]
    s_add_u32 s42, s42, 29696
    s_cmp_eq_u32 s42, 148480
    s_cselect_b32 s42, 0, s42
    s_add_u32 s45, s45, 1
    s_waitcnt vmcnt(14) lgkmcnt(0)
    s_barrier
    v_mfma_f32_16x16x32_bf16 v[140:143], v[108:111], v[96:99], v[140:143]
    ds_read_b64_tr_b16 v[244:245], v255 offset:0
    ds_read_b64_tr_b16 v[246:247], v255 offset:256
    s_add_u32 m0, s41, s46
    v_mfma_f32_16x16x32_bf16 v[144:147], v[108:111], v[100:103], v[144:147]
    buffer_load_dwordx4 v1, s[8:11], s43 offen lds
    ds_read_b64_tr_b16 v[248:249], v14 offset:0
    v_mfma_f32_16x16x32_bf16 v[148:151], v[108:111], v[104:107], v[148:151]
    ds_read_b64_tr_b16 v[250:251], v14 offset:256
    v_mfma_f32_16x16x32_bf16 v[152:155], v[112:115], v[96:99], v[152:155]
    ds_read_b128 v[52:55], v9 offset:0
    v_mfma_f32_16x16x32_bf16 v[156:159], v[112:115], v[100:103], v[156:159]
    ds_read_b128 v[56:59], v9 offset:1024
    v_mfma_f32_16x16x32_bf16 v[160:163], v[112:115], v[104:107], v[160:163]
    ds_read_b128 v[60:63], v9 offset:2048
    v_mfma_f32_16x16x32_bf16 v[164:167], v[116:119], v[96:99], v[164:167]
    ds_read_b64_tr_b16 v[64:65], v10 offset:0
    s_add_u32 m0, s41, s47
    v_mfma_f32_16x16x32_bf16 v[168:171], v[116:119], v[100:103], v[168:171]
    buffer_load_dwordx4 v2, s[8:11], s43 offen lds
    ds_read_b64_tr_b16 v[66:67], v10 offset:256
    v_mfma_f32_16x16x32_bf16 v[172:175], v[116:119], v[104:107], v[172:175]
    ds_read_b64_tr_b16 v[68:69], v11 offset:0
    v_mfma_f32_16x16x32_bf16 v[176:179], v[120:123], v[96:99], v[176:179]
    ds_read_b64_tr_b16 v[70:71], v11 offset:256
    v_mfma_f32_16x16x32_bf16 v[180:183], v[120:123], v[100:103], v[180:183]
    ds_read_b64_tr_b16 v[72:73], v10 offset:2048
    v_mfma_f32_16x16x32_bf16 v[184:187], v[120:123], v[104:107], v[184:187]
    ds_read_b64_tr_b16 v[74:75], v10 offset:2304
    v_mfma_f32_16x16x32_bf16 v[188:191], v[124:127], v[96:99], v[188:191]
    ds_read_b64_tr_b16 v[76:77], v11 offset:2048
    s_add_u32 m0, s41, s48
    v_mfma_f32_16x16x32_bf16 v[192:195], v[124:127], v[100:103], v[192:195]
    buffer_load_dwordx4 v3, s[12:15], s44 offen lds
    ds_read_b64_tr_b16 v[78:79], v11 offset:2304
    v_mfma_f32_16x16x32_bf16 v[196:199], v[124:127], v[104:107], v[196:199]
    ds_read_b64_tr_b16 v[80:81], v10 offset:4096
    v_mfma_f32_16x16x32_bf16 v[200:203], v[128:131], v[96:99], v[200:203]
    ds_read_b64_tr_b16 v[82:83], v10 offset:4352
    v_mfma_f32_16x16x32_bf16 v[204:207], v[128:131], v[100:103], v[204:207]
    ds_read_b64_tr_b16 v[84:85], v11 offset:4096
    v_mfma_f32_16x16x32_bf16 v[208:211], v[128:131], v[104:107], v[208:211]
    ds_read_b64_tr_b16 v[86:87], v11 offset:4352
    v_mfma_f32_16x16x32_bf16 v[212:215], v[132:135], v[96:99], v[212:215]
    ds_read_b64_tr_b16 v[88:89], v10 offset:6144
    s_add_u32 m0, s41, s49
    v_mfma_f32_16x16x32_bf16 v[216:219], v[132:135], v[100:103], v[216:219]
    buffer_load_dwordx4 v4, s[16:19], s44 offen lds
    ds_read_b64_tr_b16 v[90:91], v10 offset:6400
    v_mfma_f32_16x16x32_bf16 v[220:223], v[132:135], v[104:107], v[220:223]
    ds_read_b64_tr_b16 v[92:93], v11 offset:6144
    s_add_u32 s41, s41, 29696
    s_cmp_eq_u32 s41, 148480
    s_cselect_b32 s41, 0, s41
    v_mfma_f32_16x16x32_bf16 v[224:227], v[136:139], v[96:99], v[224:227]
    ds_read_b64_tr_b16 v[94:95], v11 offset:6400
    s_add_u32 s43, s43, 64
    s_add_u32 s44, s44, s50
    s_cmp_eq_u32 s43, 1280
    s_cselect_b32 s43, 0, s43
    s_cselect_b32 s44, 0, s44
    v_mfma_f32_16x16x32_bf16 v[228:231], v[136:139], v[100:103], v[228:231]
    s_add_u32 s61, s61, 1
    s_cmp_ge_u32 s61, 20
    s_cselect_b32 s43, s54, s43
    s_cselect_b32 s44, s54, s44
    v_mfma_f32_16x16x32_bf16 v[232:235], v[136:139], v[104:107], v[232:235]
    v_add_u32 v9, s42, v5
    v_add_u32 v10, s42, v6
    s_waitcnt lgkmcnt(15)
    v_mfma_f32_16x16x32_bf16 v[44:47], v[244:247], v[24:27], v[44:47]
    v_add_u32 v11, s42, v7
    v_add_u32 v255, s42, v253
    v_add_u32 v14, s42, v254
    v_mfma_f32_16x16x32_bf16 v[48:51], v[248:251], v[24:27], v[48:51]
    s_add_u32 s42, s42, 29696
    s_cmp_eq_u32 s42, 148480
    s_cselect_b32 s42, 0, s42
    s_add_u32 s45, s45, 1
    s_cmp_lt_u32 s45, 18
    s_cbranch_scc1 Q_loop
    s_waitcnt vmcnt(13) lgkmcnt(0)
    s_barrier
    v_mfma_f32_16x16x32_bf16 v[140:143], v[64:67], v[52:55], v[140:143]
    ds_read_b64_tr_b16 v[244:245], v255 offset:0
    ds_read_b64_tr_b16 v[246:247], v255 offset:256
    buffer_load_dword v15, v17, s[24:27], 0 offen sc1
    v_mfma_f32_16x16x32_bf16 v[144:147], v[64:67], v[56:59], v[144:147]
    ds_read_b64_tr_b16 v[248:249], v14 offset:0
    v_mfma_f32_16x16x32_bf16 v[148:151], v[64:67], v[60:63], v[148:151]
    ds_read_b64_tr_b16 v[250:251], v14 offset:256
    v_mfma_f32_16x16x32_bf16 v[152:155], v[68:71], v[52:55], v[152:155]
    ds_read_b128 v[96:99], v9 offset:0
    v_mfma_f32_16x16x32_bf16 v[156:159], v[68:71], v[56:59], v[156:159]
    ds_read_b128 v[100:103], v9 offset:1024
    v_mfma_f32_16x16x32_bf16 v[160:163], v[68:71], v[60:63], v[160:163]
    ds_read_b128 v[104:107], v9 offset:2048
    v_mfma_f32_16x16x32_bf16 v[164:167], v[72:75], v[52:55], v[164:167]
    ds_read_b64_tr_b16 v[108:109], v10 offset:0
    v_mfma_f32_16x16x32_bf16 v[168:171], v[72:75], v[56:59], v[168:171]
    ds_read_b64_tr_b16 v[110:111], v10 offset:256
    v_mfma_f32_16x16x32_bf16 v[172:175], v[72:75], v[60:63], v[172:175]
    ds_read_b64_tr_b16 v[112:113], v11 offset:0
    v_mfma_f32_16x16x32_bf16 v[176:179], v[76:79], v[52:55], v[176:179]
    ds_read_b64_tr_b16 v[114:115], v11 offset:256
    v_mfma_f32_16x16x32_bf16 v[180:183], v[76:79], v[56:59], v[180:183]
    ds_read_b64_tr_b16 v[116:117], v10 offset:2048
    v_mfma_f32_16x16x32_bf16 v[184:187], v[76:79], v[60:63], v[184:187]
    ds_read_b64_tr_b16 v[118:119], v10 offset:2304
    v_mfma_f32_16x16x32_bf16 v[188:191], v[80:83], v[52:55], v[188:191]
    ds_read_b64_tr_b16 v[120:121], v11 offset:2048
    v_mfma_f32_16x16x32_bf16 v[192:195], v[80:83], v[56:59], v[192:195]
    ds_read_b64_tr_b16 v[122:123], v11 offset:2304
    v_mfma_f32_16x16x32_bf16 v[196:199], v[80:83], v[60:63], v[196:199]
    ds_read_b64_tr_b16 v[124:125], v10 offset:4096
    v_mfma_f32_16x16x32_bf16 v[200:203], v[84:87], v[52:55], v[200:203]
    ds_read_b64_tr_b16 v[126:127], v10 offset:4352
    v_mfma_f32_16x16x32_bf16 v[204:207], v[84:87], v[56:59], v[204:207]
    ds_read_b64_tr_b16 v[128:129], v11 offset:4096
    v_mfma_f32_16x16x32_bf16 v[208:211], v[84:87], v[60:63], v[208:211]
    ds_read_b64_tr_b16 v[130:131], v11 offset:4352
    v_mfma_f32_16x16x32_bf16 v[212:215], v[88:91], v[52:55], v[212:215]
    ds_read_b64_tr_b16 v[132:133], v10 offset:6144
    v_mfma_f32_16x16x32_bf16 v[216:219], v[88:91], v[56:59], v[216:219]
    ds_read_b64_tr_b16 v[134:135], v10 offset:6400
    v_mfma_f32_16x16x32_bf16 v[220:223], v[88:91], v[60:63], v[220:223]
    ds_read_b64_tr_b16 v[136:137], v11 offset:6144
    v_mfma_f32_16x16x32_bf16 v[224:227], v[92:95], v[52:55], v[224:227]
    ds_read_b64_tr_b16 v[138:139], v11 offset:6400
    v_mfma_f32_16x16x32_bf16 v[228:231], v[92:95], v[56:59], v[228:231]
    v_add_u32 v9, s42, v5
    v_add_u32 v10, s42, v6
    v_mfma_f32_16x16x32_bf16 v[232:235], v[92:95], v[60:63], v[232:235]
    v_add_u32 v11, s42, v7
    v_add_u32 v255, s42, v253
    s_waitcnt lgkmcnt(15)
    v_mfma_f32_16x16x32_bf16 v[44:47], v[244:247], v[24:27], v[44:47]
    v_add_u32 v14, s42, v254
    v_mfma_f32_16x16x32_bf16 v[48:51], v[248:251], v[24:27], v[48:51]
    s_add_u32 s42, s42, 29696
    s_cmp_eq_u32 s42, 148480
    s_cselect_b32 s42, 0, s42
    s_add_u32 s45, s45, 1
    s_waitcnt vmcnt(0) lgkmcnt(0)
    s_barrier
    v_mfma_f32_16x16x32_bf16 v[140:143], v[108:111], v[96:99], v[140:143]
    ds_read_b64_tr_b16 v[244:245], v255 offset:0
    ds_read_b64_tr_b16 v[246:247], v255 offset:256
    v_readfirstlane_b32 s61, v15
    s_mov_b32 s60, 0
Q_chk:
    s_cmp_ge_u32 s61, 16
    s_cbranch_scc1 Q_ok
    s_sleep 16
    buffer_load_dword v15, v17, s[24:27], 0 offen sc1
    s_waitcnt vmcnt(0)
    v_readfirstlane_b32 s61, v15
    s_add_u32 s60, s60, 1
    s_cmp_lt_u32 s60, 0x100000
    s_cbranch_scc1 Q_chk
Q_ok:
    buffer_load_dwordx4 v[28:31], v18, s[28:31], 0 offen sc1
    buffer_load_dwordx4 v[32:35], v19, s[28:31], 0 offen sc1
    buffer_load_dwordx4 v[36:39], v20, s[28:31], 0 offen sc1
    v_mfma_f32_16x16x32_bf16 v[144:147], v[108:111], v[100:103], v[144:147]
    ds_read_b64_tr_b16 v[248:249], v14 offset:0
    v_mfma_f32_16x16x32_bf16 v[148:151], v[108:111], v[104:107], v[148:151]
    ds_read_b64_tr_b16 v[250:251], v14 offset:256
    v_mfma_f32_16x16x32_bf16 v[152:155], v[112:115], v[96:99], v[152:155]
    ds_read_b128 v[52:55], v9 offset:0
    v_mfma_f32_16x16x32_bf16 v[156:159], v[112:115], v[100:103], v[156:159]
    ds_read_b128 v[56:59], v9 offset:1024
    v_mfma_f32_16x16x32_bf16 v[160:163], v[112:115], v[104:107], v[160:163]
    ds_read_b128 v[60:63], v9 offset:2048
    v_mfma_f32_16x16x32_bf16 v[164:167], v[116:119], v[96:99], v[164:167]
    ds_read_b64_tr_b16 v[64:65], v10 offset:0
    v_mfma_f32_16x16x32_bf16 v[168:171], v[116:119], v[100:103], v[168:171]
    ds_read_b64_tr_b16 v[66:67], v10 offset:256
    v_mfma_f32_16x16x32_bf16 v[172:175], v[116:119], v[104:107], v[172:175]
    ds_read_b64_tr_b16 v[68:69], v11 offset:0
    v_mfma_f32_16x16x32_bf16 v[176:179], v[120:123], v[96:99], v[176:179]
    ds_read_b64_tr_b16 v[70:71], v11 offset:256
    v_mfma_f32_16x16x32_bf16 v[180:183], v[120:123], v[100:103], v[180:183]
    ds_read_b64_tr_b16 v[72:73], v10 offset:2048
    v_mfma_f32_16x16x32_bf16 v[184:187], v[120:123], v[104:107], v[184:187]
    ds_read_b64_tr_b16 v[74:75], v10 offset:2304
    v_mfma_f32_16x16x32_bf16 v[188:191], v[124:127], v[96:99], v[188:191]
    ds_read_b64_tr_b16 v[76:77], v11 offset:2048
    v_mfma_f32_16x16x32_bf16 v[192:195], v[124:127], v[100:103], v[192:195]
    ds_read_b64_tr_b16 v[78:79], v11 offset:2304
    v_mfma_f32_16x16x32_bf16 v[196:199], v[124:127], v[104:107], v[196:199]
    ds_read_b64_tr_b16 v[80:81], v10 offset:4096
    v_mfma_f32_16x16x32_bf16 v[200:203], v[128:131], v[96:99], v[200:203]
    ds_read_b64_tr_b16 v[82:83], v10 offset:4352
    v_mfma_f32_16x16x32_bf16 v[204:207], v[128:131], v[100:103], v[204:207]
    ds_read_b64_tr_b16 v[84:85], v11 offset:4096
    v_mfma_f32_16x16x32_bf16 v[208:211], v[128:131], v[104:107], v[208:211]
    ds_read_b64_tr_b16 v[86:87], v11 offset:4352
    v_mfma_f32_16x16x32_bf16 v[212:215], v[132:135], v[96:99], v[212:215]
    ds_read_b64_tr_b16 v[88:89], v10 offset:6144
    v_mfma_f32_16x16x32_bf16 v[216:219], v[132:135], v[100:103], v[216:219]
    ds_read_b64_tr_b16 v[90:91], v10 offset:6400
    v_mfma_f32_16x16x32_bf16 v[220:223], v[132:135], v[104:107], v[220:223]
    ds_read_b64_tr_b16 v[92:93], v11 offset:6144
    v_mfma_f32_16x16x32_bf16 v[224:227], v[136:139], v[96:99], v[224:227]
    ds_read_b64_tr_b16 v[94:95], v11 offset:6400
    v_mfma_f32_16x16x32_bf16 v[228:231], v[136:139], v[100:103], v[228:231]
    v_add_u32 v9, s42, v5
    v_add_u32 v10, s42, v6
    v_mfma_f32_16x16x32_bf16 v[232:235], v[136:139], v[104:107], v[232:235]
    v_add_u32 v11, s42, v7
    v_add_u32 v255, s42, v253
    s_waitcnt lgkmcnt(15)
    v_mfma_f32_16x16x32_bf16 v[44:47], v[244:247], v[24:27], v[44:47]
    v_add_u32 v14, s42, v254
    v_mfma_f32_16x16x32_bf16 v[48:51], v[248:251], v[24:27], v[48:51]
    s_add_u32 s42, s42, 29696
    s_cmp_eq_u32 s42, 148480
    s_cselect_b32 s42, 0, s42
    s_add_u32 s45, s45, 1
    s_branch Q_tail
Q1_entry:
    v_add_u32 v9, s42, v5
    v_add_u32 v10, s42, v6
    v_add_u32 v11, s42, v7
    v_add_u32 v255, s42, v253
    v_add_u32 v14, s42, v254
    ds_read_b64_tr_b16 v[244:245], v255 offset:0
    ds_read_b64_tr_b16 v[246:247], v255 offset:256
    ds_read_b64_tr_b16 v[248:249], v14 offset:0
    ds_read_b64_tr_b16 v[250:251], v14 offset:256
    ds_read_b128 v[52:55], v9 offset:0
    ds_read_b128 v[56:59], v9 offset:1024
    ds_read_b128 v[60:63], v9 offset:2048
    ds_read_b64_tr_b16 v[64:65], v10 offset:0
    ds_read_b64_tr_b16 v[66:67], v10 offset:256
    ds_read_b64_tr_b16 v[68:69], v11 offset:0
    ds_read_b64_tr_b16 v[70:71], v11 offset:256
    ds_read_b64_tr_b16 v[72:73], v10 offset:2048
    ds_read_b64_tr_b16 v[74:75], v10 offset:2304
    ds_read_b64_tr_b16 v[76:77], v11 offset:2048
    ds_read_b64_tr_b16 v[78:79], v11 offset:2304
    ds_read_b64_tr_b16 v[80:81], v10 offset:4096
    ds_read_b64_tr_b16 v[82:83], v10 offset:4352
    ds_read_b64_tr_b16 v[84:85], v11 offset:4096
    ds_read_b64_tr_b16 v[86:87], v11 offset:4352
    ds_read_b64_tr_b16 v[88:89], v10 offset:6144
    ds_read_b64_tr_b16 v[90:91], v10 offset:6400
    s_mov_b32 s42, 29696
    v_add_u32 v9, s42, v5
    v_add_u32 v10, s42, v6
    v_add_u32 v11, s42, v7
    v_add_u32 v255, s42, v253
    v_add_u32 v14, s42, v254
    s_waitcnt lgkmcnt(15)
    v_mfma_f32_16x16x32_bf16 v[44:47], v[244:247], v[24:27], v[44:47]
    v_mfma_f32_16x16x32_bf16 v[48:51], v[248:251], v[24:27], v[48:51]
    s_add_u32 s42, s42, 29696
    s_waitcnt vmcnt(4) lgkmcnt(0)
    s_barrier
    v_mfma_f32_16x16x32_bf16 v[140:143], v[64:67], v[52:55], v[140:143]
    buffer_load_dword v15, v16, s[80:83], s84 offen
    s_add_u32 s84, s84, s85
    s_add_u32 s87, s87, 1
    s_cmp_eq_u32 s87, 10
    s_cselect_b32 s84, s88, s84
    s_cselect_b32 s87, 0, s87
    buffer_load_dword v15, v16, s[80:83], s84 offen
    s_add_u32 s84, s84, s85
    s_add_u32 s87, s87, 1
    s_cmp_eq_u32 s87, 10
    s_cselect_b32 s84, s88, s84
    s_cselect_b32 s87, 0, s87
    ds_read_b64_tr_b16 v[244:245], v255 offset:0
    ds_read_b64_tr_b16 v[246:247], v255 offset:256
    s_add_u32 m0, s41, s46
    v_mfma_f32_16x16x32_bf16 v[144:147], v[64:67], v[56:59], v[144:147]
    buffer_load_dwordx4 v1, s[8:11], s43 offen lds
    ds_read_b64_tr_b16 v[248:249], v14 offset:0
    v_mfma_f32_16x16x32_bf16 v[148:151], v[64:67], v[60:63], v[148:151]
    ds_read_b64_tr_b16 v[250:251], v14 offset:256
    s_add_u32 m0, s41, s47
    v_mfma_f32_16x16x32_bf16 v[152:155], v[68:71], v[52:55], v[152:155]
    buffer_load_dwordx4 v2, s[8:11], s43 offen lds
    ds_read_b128 v[96:99], v9 offset:0
    v_mfma_f32_16x16x32_bf16 v[156:159], v[68:71], v[56:59], v[156:159]
    ds_read_b128 v[100:103], v9 offset:1024
    s_add_u32 m0, s41, s48
    v_mfma_f32_16x16x32_bf16 v[160:163], v[68:71], v[60:63], v[160:163]
    buffer_load_dwordx4 v3, s[12:15], s44 offen lds
    ds_read_b128 v[104:107], v9 offset:2048
    v_mfma_f32_16x16x32_bf16 v[164:167], v[72:75], v[52:55], v[164:167]
    ds_read_b64_tr_b16 v[108:109], v10 offset:0
    s_add_u32 m0, s41, s49
    v_mfma_f32_16x16x32_bf16 v[168:171], v[72:75], v[56:59], v[168:171]
    buffer_load_dwordx4 v4, s[16:19], s44 offen lds
    ds_read_b64_tr_b16 v[110:111], v10 offset:256
    v_mfma_f32_16x16x32_bf16 v[172:175], v[72:75], v[60:63], v[172:175]
    ds_read_b64_tr_b16 v[112:113], v11 offset:0
    s_add_u32 s41, s41, 29696
    s_cmp_eq_u32 s41, 148480
    s_cselect_b32 s41, 0, s41
    v_mfma_f32_16x16x32_bf16 v[176:179], v[76:79], v[52:55], v[176:179]
    ds_read_b64_tr_b16 v[114:115], v11 offset:256
    ds_read_b64_tr_b16 v[116:117], v10 offset:2048
    s_add_u32 s43, s43, 64
    s_add_u32 s44, s44, s50
    s_cmp_eq_u32 s43, 1280
    s_cselect_b32 s43, 0, s43
    s_cselect_b32 s44, 0, s44
    v_mfma_f32_16x16x32_bf16 v[180:183], v[76:79], v[56:59], v[180:183]
    ds_read_b64_tr_b16 v[118:119], v10 offset:2304
    s_add_u32 s61, s61, 1
    s_cmp_ge_u32 s61, 20
    s_cselect_b32 s43, s54, s43
    s_cselect_b32 s44, s54, s44
    s_add_u32 m0, s41, s46
    v_mfma_f32_16x16x32_bf16 v[184:187], v[76:79], v[60:63], v[184:187]
    buffer_load_dwordx4 v1, s[8:11], s43 offen lds
    ds_read_b64_tr_b16 v[120:121], v11 offset:2048
    v_mfma_f32_16x16x32_bf16 v[188:191], v[80:83], v[52:55], v[188:191]
    ds_read_b64_tr_b16 v[122:123], v11 offset:2304
    s_add_u32 m0, s41, s47
    v_mfma_f32_16x16x32_bf16 v[192:195], v[80:83], v[56:59], v[192:195]
    buffer_load_dwordx4 v2, s[8:11], s43 offen lds
    ds_read_b64_tr_b16 v[124:125], v10 offset:4096
    v_mfma_f32_16x16x32_bf16 v[196:199], v[80:83], v[60:63], v[196:199]
    ds_read_b64_tr_b16 v[126:127], v10 offset:4352
    s_add_u32 m0, s41, s48
    v_mfma_f32_16x16x32_bf16 v[200:203], v[84:87], v[52:55], v[200:203]
    buffer_load_dwordx4 v3, s[12:15], s44 offen lds
    ds_read_b64_tr_b16 v[128:129], v11 offset:4096
    v_mfma_f32_16x16x32_bf16 v[204:207], v[84:87], v[56:59], v[204:207]
    ds_read_b64_tr_b16 v[130:131], v11 offset:4352
    s_add_u32 m0, s41, s49
    v_mfma_f32_16x16x32_bf16 v[208:211], v[84:87], v[60:63], v[208:211]
    buffer_load_dwordx4 v4, s[16:19], s44 offen lds
    ds_read_b64_tr_b16 v[132:133], v10 offset:6144
    v_mfma_f32_16x16x32_bf16 v[212:215], v[88:91], v[52:55], v[212:215]
    ds_read_b64_tr_b16 v[134:135], v10 offset:6400
    s_add_u32 s41, s41, 29696
    s_cmp_eq_u32 s41, 148480
    s_cselect_b32 s41, 0, s41
    v_mfma_f32_16x16x32_bf16 v[216:219], v[88:91], v[56:59], v[216:219]
    s_add_u32 s43, s43, 64
    s_add_u32 s44, s44, s50
    s_cmp_eq_u32 s43, 1280
    s_cselect_b32 s43, 0, s43
    s_cselect_b32 s44, 0, s44
    v_mfma_f32_16x16x32_bf16 v[220:223], v[88:91], v[60:63], v[220:223]
    s_add_u32 s61, s61, 1
    s_cmp_ge_u32 s61, 20
    s_cselect_b32 s43, s54, s43
    s_cselect_b32 s44, s54, s44
    s_waitcnt lgkmcnt(15)
    v_mfma_f32_16x16x32_bf16 v[44:47], v[244:247], v[24:27], v[44:47]
    v_add_u32 v9, s42, v5
    v_add_u32 v10, s42, v6
    v_add_u32 v11, s42, v7
    v_add_u32 v255, s42, v253
    v_add_u32 v14, s42, v254
    v_mfma_f32_16x16x32_bf16 v[48:51], v[248:251], v[24:27], v[48:51]
    s_add_u32 s42, s42, 29696
    s_cmp_eq_u32 s42, 148480
    s_cselect_b32 s42, 0, s42
    s_add_u32 s45, s45, 1
    s_waitcnt vmcnt(10) lgkmcnt(0)
    s_barrier
    v_mfma_f32_16x16x32_bf16 v[140:143], v[108:111], v[96:99], v[140:143]
    buffer_load_dword v15, v16, s[80:83], s84 offen
    s_add_u32 s84, s84, s85
    s_add_u32 s87, s87, 1
    s_cmp_eq_u32 s87, 10
    s_cselect_b32 s84, s88, s84
    s_cselect_b32 s87, 0, s87
    ds_read_b64_tr_b16 v[244:245], v255 offset:0
    ds_read_b64_tr_b16 v[246:247], v255 offset:256
    s_add_u32 m0, s41, s46
    v_mfma_f32_16x16x32_bf16 v[144:147], v[108:111], v[100:103], v[144:147]
    buffer_load_dwordx4 v1, s[8:11], s43 offen lds
    ds_read_b64_tr_b16 v[248:249], v14 offset:0
    v_mfma_f32_16x16x32_bf16 v[148:151], v[108:111], v[104:107], v[148:151]
    ds_read_b64_tr_b16 v[250:251], v14 offset:256
    s_add_u32 m0, s41, s47
    v_mfma_f32_16x16x32_bf16 v[152:155], v[112:115], v[96:99], v[152:155]
    buffer_load_dwordx4 v2, s[8:11], s43 offen lds
    ds_read_b128 v[52:55], v9 offset:0
    v_mfma_f32_16x16x32_bf16 v[156:159], v[112:115], v[100:103], v[156:159]
    ds_read_b128 v[56:59], v9 offset:1024
    s_add_u32 m0, s41, s48
    v_mfma_f32_16x16x32_bf16 v[160:163], v[112:115], v[104:107], v[160:163]
    buffer_load_dwordx4 v3, s[12:15], s44 offen lds
    ds_read_b128 v[60:63], v9 offset:2048
    v_mfma_f32_16x16x32_bf16 v[164:167], v[116:119], v[96:99], v[164:167]
    ds_read_b64_tr_b16 v[64:65], v10 offset:0
    s_add_u32 m0, s41, s49
    v_mfma_f32_16x16x32_bf16 v[168:171], v[116:119], v[100:103], v[168:171]
    buffer_load_dwordx4 v4, s[16:19], s44 offen lds
    ds_read_b64_tr_b16 v[66:67], v10 offset:256
    v_mfma_f32_16x16x32_bf16 v[172:175], v[116:119], v[104:107], v[172:175]
    ds_read_b64_tr_b16 v[68:69], v11 offset:0
    s_add_u32 s41, s41, 29696
    s_cmp_eq_u32 s41, 148480
    s_cselect_b32 s41, 0, s41
    v_mfma_f32_16x16x32_bf16 v[176:179], v[120:123], v[96:99], v[176:179]
    ds_read_b64_tr_b16 v[70:71], v11 offset:256
    ds_read_b64_tr_b16 v[72:73], v10 offset:2048
    s_add_u32 s43, s43, 64
    s_add_u32 s44, s44, s50
    s_cmp_eq_u32 s43, 1280
    s_cselect_b32 s43, 0, s43
    s_cselect_b32 s44, 0, s44
    v_mfma_f32_16x16x32_bf16 v[180:183], v[120:123], v[100:103], v[180:183]
    ds_read_b64_tr_b16 v[74:75], v10 offset:2304
    s_add_u32 s61, s61, 1
    s_cmp_ge_u32 s61, 20
    s_cselect_b32 s43, s54, s43
    s_cselect_b32 s44, s54, s44
    s_add_u32 m0, s41, s46
    v_mfma_f32_16x16x32_bf16 v[184:187], v[120:123], v[104:107], v[184:187]
    buffer_load_dwordx4 v1, s[8:11], s43 offen lds
    ds_read_b64_tr_b16 v[76:77], v11 offset:2048
    v_mfma_f32_16x16x32_bf16 v[188:191], v[124:127], v[96:99], v[188:191]
    ds_read_b64_tr_b16 v[78:79], v11 offset:2304
    s_add_u32 m0, s41, s47
    v_mfma_f32_16x16x32_bf16 v[192:195], v[124:127], v[100:103], v[192:195]
    buffer_load_dwordx4 v2, s[8:11], s43 offen lds
    ds_read_b64_tr_b16 v[80:81], v10 offset:4096
    v_mfma_f32_16x16x32_bf16 v[196:199], v[124:127], v[104:107], v[196:199]
    ds_read_b64_tr_b16 v[82:83], v10 offset:4352
    s_add_u32 m0, s41, s48
    v_mfma_f32_16x16x32_bf16 v[200:203], v[128:131], v[96:99], v[200:203]
    buffer_load_dwordx4 v3, s[12:15], s44 offen lds
    ds_read_b64_tr_b16 v[84:85], v11 offset:4096
    v_mfma_f32_16x16x32_bf16 v[204:207], v[128:131], v[100:103], v[204:207]
    ds_read_b64_tr_b16 v[86:87], v11 offset:4352
    s_add_u32 m0, s41, s49
    v_mfma_f32_16x16x32_bf16 v[208:211], v[128:131], v[104:107], v[208:211]
    buffer_load_dwordx4 v4, s[16:19], s44 offen lds
    ds_read_b64_tr_b16 v[88:89], v10 offset:6144
    v_mfma_f32_16x16x32_bf16 v[212:215], v[132:135], v[96:99], v[212:215]
    ds_read_b64_tr_b16 v[90:91], v10 offset:6400
    s_add_u32 s41, s41, 29696
    s_cmp_eq_u32 s41, 148480
    s_cselect_b32 s41, 0, s41
    v_mfma_f32_16x16x32_bf16 v[216:219], v[132:135], v[100:103], v[216:219]
    s_add_u32 s43, s43, 64
    s_add_u32 s44, s44, s50
    s_cmp_eq_u32 s43, 1280
    s_cselect_b32 s43, 0, s43
    s_cselect_b32 s44, 0, s44
    v_mfma_f32_16x16x32_bf16 v[220:223], v[132:135], v[104:107], v[220:223]
    s_add_u32 s61, s61, 1
    s_cmp_ge_u32 s61, 20
    s_cselect_b32 s43, s54, s43
    s_cselect_b32 s44, s54, s44
    s_waitcnt lgkmcnt(15)
    v_mfma_f32_16x16x32_bf16 v[44:47], v[244:247], v[24:27], v[44:47]
    v_add_u32 v9, s42, v5
    v_add_u32 v10, s42, v6
    v_add_u32 v11, s42, v7
    v_add_u32 v255, s42, v253
    v_add_u32 v14, s42, v254
    v_mfma_f32_16x16x32_bf16 v[48:51], v[248:251], v[24:27], v[48:51]
    s_add_u32 s42, s42, 29696
    s_cmp_eq_u32 s42, 148480
    s_cselect_b32 s42, 0, s42
    s_add_u32 s45, s45, 1
    .p2align 3
Q1_loop:
    s_waitcnt vmcnt(13) lgkmcnt(0)
    s_barrier
    v_mfma_f32_16x16x32_bf16 v[140:143], v[64:67], v[52:55], v[140:143]
    buffer_load_dword v15, v16, s[80:83], s84 offen
    s_add_u32 s84, s84, s85
    s_add_u32 s87, s87, 1
    s_cmp_eq_u32 s87, 10
    s_cselect_b32 s84, s88, s84
    s_cselect_b32 s87, 0, s87
    ds_read_b64_tr_b16 v[244:245], v255 offset:0
    ds_read_b64_tr_b16 v[246:247], v255 offset:256
    s_add_u32 m0, s41, s46
    v_mfma_f32_16x16x32_bf16 v[144:147], v[64:67], v[56:59], v[144:147]
    buffer_load_dwordx4 v1, s[8:11], s43 offen lds
    ds_read_b64_tr_b16 v[248:249], v14 offset:0
    v_mfma_f32_16x16x32_bf16 v[148:151], v[64:67], v[60:63], v[148:151]
    ds_read_b64_tr_b16 v[250:251], v14 offset:256
    v_mfma_f32_16x16x32_bf16 v[152:155], v[68:71], v[52:55], v[152:155]
    ds_read_b128 v[96:99], v9 offset:0
    v_mfma_f32_16x16x32_bf16 v[156:159], v[68:71], v[56:59], v[156:159]
    ds_read_b128 v[100:103], v9 offset:1024
    v_mfma_f32_16x16x32_bf16 v[160:163], v[68:71], v[60:63], v[160:163]
    ds_read_b128 v[104:107], v9 offset:2048
    s_add_u32 m0, s41, s47
    v_mfma_f32_16x16x32_bf16 v[164:167], v[72:75], v[52:55], v[164:167]
    buffer_load_dwordx4 v2, s[8:11], s43 offen lds
    ds_read_b64_tr_b16 v[108:109], v10 offset:0
    v_mfma_f32_16x16x32_bf16 v[168:171], v[72:75], v[56:59], v[168:171]
    ds_read_b64_tr_b16 v[110:111], v10 offset:256
    v_mfma_f32_16x16x32_bf16 v[172:175], v[72:75], v[60:63], v[172:175]
    ds_read_b64_tr_b16 v[112:113], v11 offset:0
    v_mfma_f32_16x16x32_bf16 v[176:179], v[76:79], v[52:55], v[176:179]
    ds_read_b64_tr_b16 v[114:115], v11 offset:256
    ds_read_b64_tr_b16 v[116:117], v10 offset:2048
    v_mfma_f32_16x16x32_bf16 v[180:183], v[76:79], v[56:59], v[180:183]
    ds_read_b64_tr_b16 v[118:119], v10 offset:2304
    s_add_u32 m0, s41, s48
    v_mfma_f32_16x16x32_bf16 v[184:187], v[76:79], v[60:63], v[184:187]
    buffer_load_dwordx4 v3, s[12:15], s44 offen lds
    ds_read_b64_tr_b16 v[120:121], v11 offset:2048
    v_mfma_f32_16x16x32_bf16 v[188:191], v[80:83], v[52:55], v[188:191]
    ds_read_b64_tr_b16 v[122:123], v11 offset:2304
    v_mfma_f32_16x16x32_bf16 v[192:195], v[80:83], v[56:59], v[192:195]
    ds_read_b64_tr_b16 v[124:125], v10 offset:4096
    v_mfma_f32_16x16x32_bf16 v[196:199], v[80:83], v[60:63], v[196:199]
    ds_read_b64_tr_b16 v[126:127], v10 offset:4352
    v_mfma_f32_16x16x32_bf16 v[200:203], v[84:87], v[52:55], v[200:203]
    ds_read_b64_tr_b16 v[128:129], v11 offset:4096
    s_add_u32 m0, s41, s49
    v_mfma_f32_16x16x32_bf16 v[204:207], v[84:87], v[56:59], v[204:207]
    buffer_load_dwordx4 v4, s[16:19], s44 offen lds
    ds_read_b64_tr_b16 v[130:131], v11 offset:4352
    v_mfma_f32_16x16x32_bf16 v[208:211], v[84:87], v[60:63], v[208:211]
    ds_read_b64_tr_b16 v[132:133], v10 offset:6144
    s_add_u32 s41, s41, 29696
    s_cmp_eq_u32 s41, 148480
    s_cselect_b32 s41, 0, s41
    v_mfma_f32_16x16x32_bf16 v[212:215], v[88:91], v[52:55], v[212:215]
    ds_read_b64_tr_b16 v[134:135], v10 offset:6400
    s_add_u32 s43, s43, 64
    s_add_u32 s44, s44, s50
    s_cmp_eq_u32 s43, 1280
    s_cselect_b32 s43, 0, s43
    s_cselect_b32 s44, 0, s44
    v_mfma_f32_16x16x32_bf16 v[216:219], v[88:91], v[56:59], v[216:219]
    s_add_u32 s61, s61, 1
    s_cmp_ge_u32 s61, 20
    s_cselect_b32 s43, s54, s43
    s_cselect_b32 s44, s54, s44
    v_mfma_f32_16x16x32_bf16 v[220:223], v[88:91], v[60:63], v[220:223]
    v_add_u32 v9, s42, v5
    v_add_u32 v10, s42, v6
    s_waitcnt lgkmcnt(15)
    v_mfma_f32_16x16x32_bf16 v[44:47], v[244:247], v[24:27], v[44:47]
    v_add_u32 v11, s42, v7
    v_add_u32 v255, s42, v253
    v_add_u32 v14, s42, v254
    v_mfma_f32_16x16x32_bf16 v[48:51], v[248:251], v[24:27], v[48:51]
    s_add_u32 s42, s42, 29696
    s_cmp_eq_u32 s42, 148480
    s_cselect_b32 s42, 0, s42
    s_add_u32 s45, s45, 1
    s_waitcnt vmcnt(14) lgkmcnt(0)
    s_barrier
    v_mfma_f32_16x16x32_bf16 v[140:143], v[108:111], v[96:99], v[140:143]
    ds_read_b64_tr_b16 v[244:245], v255 offset:0
    ds_read_b64_tr_b16 v[246:247], v255 offset:256
    s_add_u32 m0, s41, s46
    v_mfma_f32_16x16x32_bf16 v[144:147], v[108:111], v[100:103], v[144:147]
    buffer_load_dwordx4 v1, s[8:11], s43 offen lds
    ds_read_b64_tr_b16 v[248:249], v14 offset:0
    v_mfma_f32_16x16x32_bf16 v[148:151], v[108:111], v[104:107], v[148:151]
    ds_read_b64_tr_b16 v[250:251], v14 offset:256
    v_mfma_f32_16x16x32_bf16 v[152:155], v[112:115], v[96:99], v[152:155]
    ds_read_b128 v[52:55], v9 offset:0
    v_mfma_f32_16x16x32_bf16 v[156:159], v[112:115], v[100:103], v[156:159]
    ds_read_b128 v[56:59], v9 offset:1024
    v_mfma_f32_16x16x32_bf16 v[160:163], v[112:115], v[104:107], v[160:163]
    ds_read_b128 v[60:63], v9 offset:2048
    s_add_u32 m0, s41, s47
    v_mfma_f32_16x16x32_bf16 v[164:167], v[116:119], v[96:99], v[164:167]
    buffer_load_dwordx4 v2, s[8:11], s43 offen lds
    ds_read_b64_tr_b16 v[64:65], v10 offset:0
    v_mfma_f32_16x16x32_bf16 v[168:171], v[116:119], v[100:103], v[168:171]
    ds_read_b64_tr_b16 v[66:67], v10 offset:256
    v_mfma_f32_16x16x32_bf16 v[172:175], v[116:119], v[104:107], v[172:175]
    ds_read_b64_tr_b16 v[68:69], v11 offset:0
    v_mfma_f32_16x16x32_bf16 v[176:179], v[120:123], v[96:99], v[176:179]
    ds_read_b64_tr_b16 v[70:71], v11 offset:256
    ds_read_b64_tr_b16 v[72:73], v10 offset:2048
    v_mfma_f32_16x16x32_bf16 v[180:183], v[120:123], v[100:103], v[180:183]
    ds_read_b64_tr_b16 v[74:75], v10 offset:2304
    s_add_u32 m0, s41, s48
    v_mfma_f32_16x16x32_bf16 v[184:187], v[120:123], v[104:107], v[184:187]
    buffer_load_dwordx4 v3, s[12:15], s44 offen lds
    ds_read_b64_tr_b16 v[76:77], v11 offset:2048
    v_mfma_f32_16x16x32_bf16 v[188:191], v[124:127], v[96:99], v[188:191]
    ds_read_b64_tr_b16 v[78:79], v11 offset:2304
    v_mfma_f32_16x16x32_bf16 v[192:195], v[124:127], v[100:103], v[192:195]
    ds_read_b64_tr_b16 v[80:81], v10 offset:4096
    v_mfma_f32_16x16x32_bf16 v[196:199], v[124:127], v[104:107], v[196:199]
    ds_read_b64_tr_b16 v[82:83], v10 offset:4352
    v_mfma_f32_16x16x32_bf16 v[200:203], v[128:131], v[96:99], v[200:203]
    ds_read_b64_tr_b16 v[84:85], v11 offset:4096
    s_add_u32 m0, s41, s49
    v_mfma_f32_16x16x32_bf16 v[204:207], v[128:131], v[100:103], v[204:207]
    buffer_load_dwordx4 v4, s[16:19], s44 offen lds
    ds_read_b64_tr_b16 v[86:87], v11 offset:4352
    v_mfma_f32_16x16x32_bf16 v[208:211], v[128:131], v[104:107], v[208:211]
    ds_read_b64_tr_b16 v[88:89], v10 offset:6144
    s_add_u32 s41, s41, 29696
    s_cmp_eq_u32 s41, 148480
    s_cselect_b32 s41, 0, s41
    v_mfma_f32_16x16x32_bf16 v[212:215], v[132:135], v[96:99], v[212:215]
    ds_read_b64_tr_b16 v[90:91], v10 offset:6400
    s_add_u32 s43, s43, 64
    s_add_u32 s44, s44, s50
    s_cmp_eq_u32 s43, 1280
    s_cselect_b32 s43, 0, s43
    s_cselect_b32 s44, 0, s44
    v_mfma_f32_16x16x32_bf16 v[216:219], v[132:135], v[100:103], v[216:219]
    s_add_u32 s61, s61, 1
    s_cmp_ge_u32 s61, 20
    s_cselect_b32 s43, s54, s43
    s_cselect_b32 s44, s54, s44
    v_mfma_f32_16x16x32_bf16 v[220:223], v[132:135], v[104:107], v[220:223]
    v_add_u32 v9, s42, v5
    v_add_u32 v10, s42, v6
    s_waitcnt lgkmcnt(15)
    v_mfma_f32_16x16x32_bf16 v[44:47], v[244:247], v[24:27], v[44:47]
    v_add_u32 v11, s42, v7
    v_add_u32 v255, s42, v253
    v_add_u32 v14, s42, v254
    v_mfma_f32_16x16x32_bf16 v[48:51], v[248:251], v[24:27], v[48:51]
    s_add_u32 s42, s42, 29696
    s_cmp_eq_u32 s42, 148480
    s_cselect_b32 s42, 0, s42
    s_add_u32 s45, s45, 1
    s_cmp_lt_u32 s45, 18
    s_cbranch_scc1 Q1_loop
    s_waitcnt vmcnt(13) lgkmcnt(0)
    s_barrier
    v_mfma_f32_16x16x32_bf16 v[140:143], v[64:67], v[52:55], v[140:143]
    ds_read_b64_tr_b16 v[244:245], v255 offset:0
    ds_read_b64_tr_b16 v[246:247], v255 offset:256
    buffer_load_dword v15, v17, s[24:27], 0 offen sc1
    v_mfma_f32_16x16x32_bf16 v[144:147], v[64:67], v[56:59], v[144:147]
    ds_read_b64_tr_b16 v[248:249], v14 offset:0
    v_mfma_f32_16x16x32_bf16 v[148:151], v[64:67], v[60:63], v[148:151]
    ds_read_b64_tr_b16 v[250:251], v14 offset:256
    v_mfma_f32_16x16x32_bf16 v[152:155], v[68:71], v[52:55], v[152:155]
    ds_read_b128 v[96:99], v9 offset:0
    v_mfma_f32_16x16x32_bf16 v[156:159], v[68:71], v[56:59], v[156:159]
    ds_read_b128 v[100:103], v9 offset:1024
    v_mfma_f32_16x16x32_bf16 v[160:163], v[68:71], v[60:63], v[160:163]
    ds_read_b128 v[104:107], v9 offset:2048
    v_mfma_f32_16x16x32_bf16 v[164:167], v[72:75], v[52:55], v[164:167]
    ds_read_b64_tr_b16 v[108:109], v10 offset:0
    v_mfma_f32_16x16x32_bf16 v[168:171], v[72:75], v[56:59], v[168:171]
    ds_read_b64_tr_b16 v[110:111], v10 offset:256
    v_mfma_f32_16x16x32_bf16 v[172:175], v[72:75], v[60:63], v[172:175]
    ds_read_b64_tr_b16 v[112:113], v11 offset:0
    v_mfma_f32_16x16x32_bf16 v[176:179], v[76:79], v[52:55], v[176:179]
    ds_read_b64_tr_b16 v[114:115], v11 offset:256
    ds_read_b64_tr_b16 v[116:117], v10 offset:2048
    v_mfma_f32_16x16x32_bf16 v[180:183], v[76:79], v[56:59], v[180:183]
    ds_read_b64_tr_b16 v[118:119], v10 offset:2304
    v_mfma_f32_16x16x32_bf16 v[184:187], v[76:79], v[60:63], v[184:187]
    ds_read_b64_tr_b16 v[120:121], v11 offset:2048
    v_mfma_f32_16x16x32_bf16 v[188:191], v[80:83], v[52:55], v[188:191]
    ds_read_b64_tr_b16 v[122:123], v11 offset:2304
    v_mfma_f32_16x16x32_bf16 v[192:195], v[80:83], v[56:59], v[192:195]
    ds_read_b64_tr_b16 v[124:125], v10 offset:4096
    v_mfma_f32_16x16x32_bf16 v[196:199], v[80:83], v[60:63], v[196:199]
    ds_read_b64_tr_b16 v[126:127], v10 offset:4352
    v_mfma_f32_16x16x32_bf16 v[200:203], v[84:87], v[52:55], v[200:203]
    ds_read_b64_tr_b16 v[128:129], v11 offset:4096
    v_mfma_f32_16x16x32_bf16 v[204:207], v[84:87], v[56:59], v[204:207]
    ds_read_b64_tr_b16 v[130:131], v11 offset:4352
    v_mfma_f32_16x16x32_bf16 v[208:211], v[84:87], v[60:63], v[208:211]
    ds_read_b64_tr_b16 v[132:133], v10 offset:6144
    v_mfma_f32_16x16x32_bf16 v[212:215], v[88:91], v[52:55], v[212:215]
    ds_read_b64_tr_b16 v[134:135], v10 offset:6400
    v_mfma_f32_16x16x32_bf16 v[216:219], v[88:91], v[56:59], v[216:219]
    v_add_u32 v9, s42, v5
    v_add_u32 v10, s42, v6
    v_mfma_f32_16x16x32_bf16 v[220:223], v[88:91], v[60:63], v[220:223]
    v_add_u32 v11, s42, v7
    v_add_u32 v255, s42, v253
    s_waitcnt lgkmcnt(15)
    v_mfma_f32_16x16x32_bf16 v[44:47], v[244:247], v[24:27], v[44:47]
    v_add_u32 v14, s42, v254
    v_mfma_f32_16x16x32_bf16 v[48:51], v[248:251], v[24:27], v[48:51]
    s_add_u32 s42, s42, 29696
    s_cmp_eq_u32 s42, 148480
    s_cselect_b32 s42, 0, s42
    s_add_u32 s45, s45, 1
    s_waitcnt vmcnt(0) lgkmcnt(0)
    s_barrier
    v_mfma_f32_16x16x32_bf16 v[140:143], v[108:111], v[96:99], v[140:143]
    ds_read_b64_tr_b16 v[244:245], v255 offset:0
    ds_read_b64_tr_b16 v[246:247], v255 offset:256
    v_readfirstlane_b32 s61, v15
    s_mov_b32 s60, 0
Q1_chk:
    s_cmp_ge_u32 s61, 16
    s_cbranch_scc1 Q1_ok
    s_sleep 16
    buffer_load_dword v15, v17, s[24:27], 0 offen sc1
    s_waitcnt vmcnt(0)
    v_readfirstlane_b32 s61, v15
    s_add_u32 s60, s60, 1
    s_cmp_lt_u32 s60, 0x100000
    s_cbranch_scc1 Q1_chk
Q1_ok:
    buffer_load_dwordx4 v[28:31], v18, s[28:31], 0 offen sc1
    buffer_load_dwordx4 v[32:35], v19, s[28:31], 0 offen sc1
    buffer_load_dwordx4 v[36:39], v20, s[28:31], 0 offen sc1
    v_mfma_f32_16x16x32_bf16 v[144:147], v[108:111], v[100:103], v[144:147]
    ds_read_b64_tr_b16 v[248:249], v14 offset:0
    v_mfma_f32_16x16x32_bf16 v[148:151], v[108:111], v[104:107], v[148:151]
    ds_read_b64_tr_b16 v[250:251], v14 offset:256
    v_mfma_f32_16x16x32_bf16 v[152:155], v[112:115], v[96:99], v[152:155]
    ds_read_b128 v[52:55], v9 offset:0
    v_mfma_f32_16x16x32_bf16 v[156:159], v[112:115], v[100:103], v[156:159]
    ds_read_b128 v[56:59], v9 offset:1024
    v_mfma_f32_16x16x32_bf16 v[160:163], v[112:115], v[104:107], v[160:163]
    ds_read_b128 v[60:63], v9 offset:2048
    v_mfma_f32_16x16x32_bf16 v[164:167], v[116:119], v[96:99], v[164:167]
    ds_read_b64_tr_b16 v[64:65], v10 offset:0
    v_mfma_f32_16x16x32_bf16 v[168:171], v[116:119], v[100:103], v[168:171]
    ds_read_b64_tr_b16 v[66:67], v10 offset:256
    v_mfma_f32_16x16x32_bf16 v[172:175], v[116:119], v[104:107], v[172:175]
    ds_read_b64_tr_b16 v[68:69], v11 offset:0
    v_mfma_f32_16x16x32_bf16 v[176:179], v[120:123], v[96:99], v[176:179]
    ds_read_b64_tr_b16 v[70:71], v11 offset:256
    ds_read_b64_tr_b16 v[72:73], v10 offset:2048
    v_mfma_f32_16x16x32_bf16 v[180:183], v[120:123], v[100:103], v[180:183]
    ds_read_b64_tr_b16 v[74:75], v10 offset:2304
    v_mfma_f32_16x16x32_bf16 v[184:187], v[120:123], v[104:107], v[184:187]
    ds_read_b64_tr_b16 v[76:77], v11 offset:2048
    v_mfma_f32_16x16x32_bf16 v[188:191], v[124:127], v[96:99], v[188:191]
    ds_read_b64_tr_b16 v[78:79], v11 offset:2304
    v_mfma_f32_16x16x32_bf16 v[192:195], v[124:127], v[100:103], v[192:195]
    ds_read_b64_tr_b16 v[80:81], v10 offset:4096
    v_mfma_f32_16x16x32_bf16 v[196:199], v[124:127], v[104:107], v[196:199]
    ds_read_b64_tr_b16 v[82:83], v10 offset:4352
    v_mfma_f32_16x16x32_bf16 v[200:203], v[128:131], v[96:99], v[200:203]
    ds_read_b64_tr_b16 v[84:85], v11 offset:4096
    v_mfma_f32_16x16x32_bf16 v[204:207], v[128:131], v[100:103], v[204:207]
    ds_read_b64_tr_b16 v[86:87], v11 offset:4352
    v_mfma_f32_16x16x32_bf16 v[208:211], v[128:131], v[104:107], v[208:211]
    ds_read_b64_tr_b16 v[88:89], v10 offset:6144
    v_mfma_f32_16x16x32_bf16 v[212:215], v[132:135], v[96:99], v[212:215]
    ds_read_b64_tr_b16 v[90:91], v10 offset:6400
    v_mfma_f32_16x16x32_bf16 v[216:219], v[132:135], v[100:103], v[216:219]
    v_add_u32 v9, s42, v5
    v_add_u32 v10, s42, v6
    v_mfma_f32_16x16x32_bf16 v[220:223], v[132:135], v[104:107], v[220:223]
    v_add_u32 v11, s42, v7
    v_add_u32 v255, s42, v253
    s_waitcnt lgkmcnt(15)
    v_mfma_f32_16x16x32_bf16 v[44:47], v[244:247], v[24:27], v[44:47]
    v_add_u32 v14, s42, v254
    v_mfma_f32_16x16x32_bf16 v[48:51], v[248:251], v[24:27], v[48:51]
    s_add_u32 s42, s42, 29696
    s_cmp_eq_u32 s42, 148480
    s_cselect_b32 s42, 0, s42
    s_add_u32 s45, s45, 1
Q_tail:
    s_waitcnt vmcnt(0) lgkmcnt(0)
    s_barrier
    s_nop 7
    v_and_b32 v18, 15, v0
    v_lshrrev_b32 v17, 4, v0
    s_lshl_b32 s51, s40, 9
    s_add_u32 s51, s51, 152576
    v_lshlrev_b32 v16, 4, v17
    v_add_u32 v16, s51, v16
    s_lshl_b32 s51, s39, 7
    v_add_u32 v19, s51, v16
    v_cmp_eq_u32 vcc, 0, v18
    s_nop 1
    s_and_saveexec_b64 s[62:63], vcc
    ds_write_b128 v19, v[44:47]
    ds_write_b128 v19, v[48:51] offset:64
    s_mov_b64 exec, s[62:63]
    s_waitcnt lgkmcnt(0)
    s_barrier
    ds_read_b128 v[68:71], v16 offset:0
    ds_read_b128 v[72:75], v16 offset:64
    ds_read_b128 v[76:79], v16 offset:128
    ds_read_b128 v[80:83], v16 offset:192
    ds_read_b128 v[84:87], v16 offset:256
    ds_read_b128 v[88:91], v16 offset:320
    ds_read_b128 v[92:95], v16 offset:384
    ds_read_b128 v[96:99], v16 offset:448
    s_waitcnt lgkmcnt(0)
    s_cmp_eq_u32 s40, 1
    s_cbranch_scc1 Q_ep1
    v_fma_f32 v140, v28, v68, v140
    v_fma_f32 v141, v28, v69, v141
    v_fma_f32 v142, v28, v70, v142
    v_fma_f32 v143, v28, v71, v143
    v_mul_f32 v140, v140, v29
    v_mul_f32 v141, v141, v29
    v_mul_f32 v142, v142, v29
    v_mul_f32 v143, v143, v29
    v_cvt_pk_bf16_f32 v140, v140, v141
    v_cvt_pk_bf16_f32 v141, v142, v143
    ds_write_b64 v236, v[140:141] offset:0
    v_fma_f32 v144, v32, v68, v144
    v_fma_f32 v145, v32, v69, v145
    v_fma_f32 v146, v32, v70, v146
    v_fma_f32 v147, v32, v71, v147
    v_mul_f32 v144, v144, v33
    v_mul_f32 v145, v145, v33
    v_mul_f32 v146, v146, v33
    v_mul_f32 v147, v147, v33
    v_cvt_pk_bf16_f32 v144, v144, v145
    v_cvt_pk_bf16_f32 v145, v146, v147
    ds_write_b64 v236, v[144:145] offset:768
    v_fma_f32 v148, v36, v68, v148
    v_fma_f32 v149, v36, v69, v149
    v_fma_f32 v150, v36, v70, v150
    v_fma_f32 v151, v36, v71, v151
    v_mul_f32 v148, v148, v37
    v_mul_f32 v149, v149, v37
    v_mul_f32 v150, v150, v37
    v_mul_f32 v151, v151, v37
    v_cvt_pk_bf16_f32 v148, v148, v149
    v_cvt_pk_bf16_f32 v149, v150, v151
    ds_write_b64 v236, v[148:149] offset:1536
    v_fma_f32 v152, v28, v72, v152
    v_fma_f32 v153, v28, v73, v153
    v_fma_f32 v154, v28, v74, v154
    v_fma_f32 v155, v28, v75, v155
    v_mul_f32 v152, v152, v29
    v_mul_f32 v153, v153, v29
    v_mul_f32 v154, v154, v29
    v_mul_f32 v155, v155, v29
    v_cvt_pk_bf16_f32 v152, v152, v153
    v_cvt_pk_bf16_f32 v153, v154, v155
    ds_write_b64 v237, v[152:153] offset:0
    v_fma_f32 v156, v32, v72, v156
    v_fma_f32 v157, v32, v73, v157
    v_fma_f32 v158, v32, v74, v158
    v_fma_f32 v159, v32, v75, v159
    v_mul_f32 v156, v156, v33
    v_mul_f32 v157, v157, v33
    v_mul_f32 v158, v158, v33
    v_mul_f32 v159, v159, v33
    v_cvt_pk_bf16_f32 v156, v156, v157
    v_cvt_pk_bf16_f32 v157, v158, v159
    ds_write_b64 v237, v[156:157] offset:768
    v_fma_f32 v160, v36, v72, v160
    v_fma_f32 v161, v36, v73, v161
    v_fma_f32 v162, v36, v74, v162
    v_fma_f32 v163, v36, v75, v163
    v_mul_f32 v160, v160, v37
    v_mul_f32 v161, v161, v37
    v_mul_f32 v162, v162, v37
    v_mul_f32 v163, v163, v37
    v_cvt_pk_bf16_f32 v160, v160, v161
    v_cvt_pk_bf16_f32 v161, v162, v163
    ds_write_b64 v237, v[160:161] offset:1536
    v_fma_f32 v164, v28, v76, v164
    v_fma_f32 v165, v28, v77, v165
    v_fma_f32 v166, v28, v78, v166
    v_fma_f32 v167, v28, v79, v167
    v_mul_f32 v164, v164, v29
    v_mul_f32 v165, v165, v29
    v_mul_f32 v166, v166, v29
    v_mul_f32 v167, v167, v29
    v_cvt_pk_bf16_f32 v164, v164, v165
    v_cvt_pk_bf16_f32 v165, v166, v167
    ds_write_b64 v238, v[164:165] offset:0
    v_fma_f32 v168, v32, v76, v168
    v_fma_f32 v169, v32, v77, v169
    v_fma_f32 v170, v32, v78, v170
    v_fma_f32 v171, v32, v79, v171
    v_mul_f32 v168, v168, v33
    v_mul_f32 v169, v169, v33
    v_mul_f32 v170, v170, v33
    v_mul_f32 v171, v171, v33
    v_cvt_pk_bf16_f32 v168, v168, v169
    v_cvt_pk_bf16_f32 v169, v170, v171
    ds_write_b64 v238, v[168:169] offset:768
    v_fma_f32 v172, v36, v76, v172
    v_fma_f32 v173, v36, v77, v173
    v_fma_f32 v174, v36, v78, v174
    v_fma_f32 v175, v36, v79, v175
    v_mul_f32 v172, v172, v37
    v_mul_f32 v173, v173, v37
    v_mul_f32 v174, v174, v37
    v_mul_f32 v175, v175, v37
    v_cvt_pk_bf16_f32 v172, v172, v173
    v_cvt_pk_bf16_f32 v173, v174, v175
    ds_write_b64 v238, v[172:173] offset:1536
    v_fma_f32 v176, v28, v80, v176
    v_fma_f32 v177, v28, v81, v177
    v_fma_f32 v178, v28, v82, v178
    v_fma_f32 v179, v28, v83, v179
    v_mul_f32 v176, v176, v29
    v_mul_f32 v177, v177, v29
    v_mul_f32 v178, v178, v29
    v_mul_f32 v179, v179, v29
    v_cvt_pk_bf16_f32 v176, v176, v177
    v_cvt_pk_bf16_f32 v177, v178, v179
    ds_write_b64 v239, v[176:177] offset:0
    v_fma_f32 v180, v32, v80, v180
    v_fma_f32 v181, v32, v81, v181
    v_fma_f32 v182, v32, v82, v182
    v_fma_f32 v183, v32, v83, v183
    v_mul_f32 v180, v180, v33
    v_mul_f32 v181, v181, v33
    v_mul_f32 v182, v182, v33
    v_mul_f32 v183, v183, v33
    v_cvt_pk_bf16_f32 v180, v180, v181
    v_cvt_pk_bf16_f32 v181, v182, v183
    ds_write_b64 v239, v[180:181] offset:768
    v_fma_f32 v184, v36, v80, v184
    v_fma_f32 v185, v36, v81, v185
    v_fma_f32 v186, v36, v82, v186
    v_fma_f32 v187, v36, v83, v187
    v_mul_f32 v184, v184, v37
    v_mul_f32 v185, v185, v37
    v_mul_f32 v186, v186, v37
    v_mul_f32 v187, v187, v37
    v_cvt_pk_bf16_f32 v184, v184, v185
    v_cvt_pk_bf16_f32 v185, v186, v187
    ds_write_b64 v239, v[184:185] offset:1536
    v_fma_f32 v188, v28, v84, v188
    v_fma_f32 v189, v28, v85, v189
    v_fma_f32 v190, v28, v86, v190
    v_fma_f32 v191, v28, v87, v191
    v_mul_f32 v188, v188, v29
    v_mul_f32 v189, v189, v29
    v_mul_f32 v190, v190, v29
    v_mul_f32 v191, v191, v29
    v_cvt_pk_bf16_f32 v188, v188, v189
    v_cvt_pk_bf16_f32 v189, v190, v191
    ds_write_b64 v240, v[188:189] offset:0
    v_fma_f32 v192, v32, v84, v192
    v_fma_f32 v193, v32, v85, v193
    v_fma_f32 v194, v32, v86, v194
    v_fma_f32 v195, v32, v87, v195
    v_mul_f32 v192, v192, v33
    v_mul_f32 v193, v193, v33
    v_mul_f32 v194, v194, v33
    v_mul_f32 v195, v195, v33
    v_cvt_pk_bf16_f32 v192, v192, v193
    v_cvt_pk_bf16_f32 v193, v194, v195
    ds_write_b64 v240, v[192:193] offset:768
    v_fma_f32 v196, v36, v84, v196
    v_fma_f32 v197, v36, v85, v197
    v_fma_f32 v198, v36, v86, v198
    v_fma_f32 v199, v36, v87, v199
    v_mul_f32 v196, v196, v37
    v_mul_f32 v197, v197, v37
    v_mul_f32 v198, v198, v37
    v_mul_f32 v199, v199, v37
    v_cvt_pk_bf16_f32 v196, v196, v197
    v_cvt_pk_bf16_f32 v197, v198, v199
    ds_write_b64 v240, v[196:197] offset:1536
    v_fma_f32 v200, v28, v88, v200
    v_fma_f32 v201, v28, v89, v201
    v_fma_f32 v202, v28, v90, v202
    v_fma_f32 v203, v28, v91, v203
    v_mul_f32 v200, v200, v29
    v_mul_f32 v201, v201, v29
    v_mul_f32 v202, v202, v29
    v_mul_f32 v203, v203, v29
    v_cvt_pk_bf16_f32 v200, v200, v201
    v_cvt_pk_bf16_f32 v201, v202, v203
    ds_write_b64 v236, v[200:201] offset:36864
    v_fma_f32 v204, v32, v88, v204
    v_fma_f32 v205, v32, v89, v205
    v_fma_f32 v206, v32, v90, v206
    v_fma_f32 v207, v32, v91, v207
    v_mul_f32 v204, v204, v33
    v_mul_f32 v205, v205, v33
    v_mul_f32 v206, v206, v33
    v_mul_f32 v207, v207, v33
    v_cvt_pk_bf16_f32 v204, v204, v205
    v_cvt_pk_bf16_f32 v205, v206, v207
    ds_write_b64 v236, v[204:205] offset:37632
    v_fma_f32 v208, v36, v88, v208
    v_fma_f32 v209, v36, v89, v209
    v_fma_f32 v210, v36, v90, v210
    v_fma_f32 v211, v36, v91, v211
    v_mul_f32 v208, v208, v37
    v_mul_f32 v209, v209, v37
    v_mul_f32 v210, v210, v37
    v_mul_f32 v211, v211, v37
    v_cvt_pk_bf16_f32 v208, v208, v209
    v_cvt_pk_bf16_f32 v209, v210, v211
    ds_write_b64 v236, v[208:209] offset:38400
    v_fma_f32 v212, v28, v92, v212
    v_fma_f32 v213, v28, v93, v213
    v_fma_f32 v214, v28, v94, v214
    v_fma_f32 v215, v28, v95, v215
    v_mul_f32 v212, v212, v29
    v_mul_f32 v213, v213, v29
    v_mul_f32 v214, v214, v29
    v_mul_f32 v215, v215, v29
    v_cvt_pk_bf16_f32 v212, v212, v213
    v_cvt_pk_bf16_f32 v213, v214, v215
    ds_write_b64 v237, v[212:213] offset:36864
    v_fma_f32 v216, v32, v92, v216
    v_fma_f32 v217, v32, v93, v217
    v_fma_f32 v218, v32, v94, v218
    v_fma_f32 v219, v32, v95, v219
    v_mul_f32 v216, v216, v33
    v_mul_f32 v217, v217, v33
    v_mul_f32 v218, v218, v33
    v_mul_f32 v219, v219, v33
    v_cvt_pk_bf16_f32 v216, v216, v217
    v_cvt_pk_bf16_f32 v217, v218, v219
    ds_write_b64 v237, v[216:217] offset:37632
    v_fma_f32 v220, v36, v92, v220
    v_fma_f32 v221, v36, v93, v221
    v_fma_f32 v222, v36, v94, v222
    v_fma_f32 v223, v36, v95, v223
    v_mul_f32 v220, v220, v37
    v_mul_f32 v221, v221, v37
    v_mul_f32 v222, v222, v37
    v_mul_f32 v223, v223, v37
    v_cvt_pk_bf16_f32 v220, v220, v221
    v_cvt_pk_bf16_f32 v221, v222, v223
    ds_write_b64 v237, v[220:221] offset:38400
    v_fma_f32 v224, v28, v96, v224
    v_fma_f32 v225, v28, v97, v225
    v_fma_f32 v226, v28, v98, v226
    v_fma_f32 v227, v28, v99, v227
    v_mul_f32 v224, v224, v29
    v_mul_f32 v225, v225, v29
    v_mul_f32 v226, v226, v29
    v_mul_f32 v227, v227, v29
    v_cvt_pk_bf16_f32 v224, v224, v225
    v_cvt_pk_bf16_f32 v225, v226, v227
    ds_write_b64 v238, v[224:225] offset:36864
    v_fma_f32 v228, v32, v96, v228
    v_fma_f32 v229, v32, v97, v229
    v_fma_f32 v230, v32, v98, v230
    v_fma_f32 v231, v32, v99, v231
    v_mul_f32 v228, v228, v33
    v_mul_f32 v229, v229, v33
    v_mul_f32 v230, v230, v33
    v_mul_f32 v231, v231, v33
    v_cvt_pk_bf16_f32 v228, v228, v229
    v_cvt_pk_bf16_f32 v229, v230, v231
    ds_write_b64 v238, v[228:229] offset:37632
    v_fma_f32 v232, v36, v96, v232
    v_fma_f32 v233, v36, v97, v233
    v_fma_f32 v234, v36, v98, v234
    v_fma_f32 v235, v36, v99, v235
    v_mul_f32 v232, v232, v37
    v_mul_f32 v233, v233, v37
    v_mul_f32 v234, v234, v37
    v_mul_f32 v235, v235, v37
    v_cvt_pk_bf16_f32 v232, v232, v233
    v_cvt_pk_bf16_f32 v233, v234, v235
    ds_write_b64 v238, v[232:233] offset:38400
    s_branch Q_ep_done
Q_ep1:
    v_fma_f32 v140, v28, v68, v140
    v_fma_f32 v141, v28, v69, v141
    v_fma_f32 v142, v28, v70, v142
    v_fma_f32 v143, v28, v71, v143
    v_mul_f32 v140, v140, v29
    v_mul_f32 v141, v141, v29
    v_mul_f32 v142, v142, v29
    v_mul_f32 v143, v143, v29
    v_cvt_pk_bf16_f32 v140, v140, v141
    v_cvt_pk_bf16_f32 v141, v142, v143
    ds_write_b64 v239, v[140:141] offset:36864
    v_fma_f32 v144, v32, v68, v144
    v_fma_f32 v145, v32, v69, v145
    v_fma_f32 v146, v32, v70, v146
    v_fma_f32 v147, v32, v71, v147
    v_mul_f32 v144, v144, v33
    v_mul_f32 v145, v145, v33
    v_mul_f32 v146, v146, v33
    v_mul_f32 v147, v147, v33
    v_cvt_pk_bf16_f32 v144, v144, v145
    v_cvt_pk_bf16_f32 v145, v146, v147
    ds_write_b64 v239, v[144:145] offset:37632
    v_fma_f32 v148, v36, v68, v148
    v_fma_f32 v149, v36, v69, v149
    v_fma_f32 v150, v36, v70, v150
    v_fma_f32 v151, v36, v71, v151
    v_mul_f32 v148, v148, v37
    v_mul_f32 v149, v149, v37
    v_mul_f32 v150, v150, v37
    v_mul_f32 v151, v151, v37
    v_cvt_pk_bf16_f32 v148, v148, v149
    v_cvt_pk_bf16_f32 v149, v150, v151
    ds_write_b64 v239, v[148:149] offset:38400
    v_fma_f32 v152, v28, v72, v152
    v_fma_f32 v153, v28, v73, v153
    v_fma_f32 v154, v28, v74, v154
    v_fma_f32 v155, v28, v75, v155
    v_mul_f32 v152, v152, v29
    v_mul_f32 v153, v153, v29
    v_mul_f32 v154, v154, v29
    v_mul_f32 v155, v155, v29
    v_cvt_pk_bf16_f32 v152, v152, v153
    v_cvt_pk_bf16_f32 v153, v154, v155
    ds_write_b64 v240, v[152:153] offset:36864
    v_fma_f32 v156, v32, v72, v156
    v_fma_f32 v157, v32, v73, v157
    v_fma_f32 v158, v32, v74, v158
    v_fma_f32 v159, v32, v75, v159
    v_mul_f32 v156, v156, v33
    v_mul_f32 v157, v157, v33
    v_mul_f32 v158, v158, v33
    v_mul_f32 v159, v159, v33
    v_cvt_pk_bf16_f32 v156, v156, v157
    v_cvt_pk_bf16_f32 v157, v158, v159
    ds_write_b64 v240, v[156:157] offset:37632
    v_fma_f32 v160, v36, v72, v160
    v_fma_f32 v161, v36, v73, v161
    v_fma_f32 v162, v36, v74, v162
    v_fma_f32 v163, v36, v75, v163
    v_mul_f32 v160, v160, v37
    v_mul_f32 v161, v161, v37
    v_mul_f32 v162, v162, v37
    v_mul_f32 v163, v163, v37
    v_cvt_pk_bf16_f32 v160, v160, v161
    v_cvt_pk_bf16_f32 v161, v162, v163
    ds_write_b64 v240, v[160:161] offset:38400
    v_fma_f32 v164, v28, v76, v164
    v_fma_f32 v165, v28, v77, v165
    v_fma_f32 v166, v28, v78, v166
    v_fma_f32 v167, v28, v79, v167
    v_mul_f32 v164, v164, v29
    v_mul_f32 v165, v165, v29
    v_mul_f32 v166, v166, v29
    v_mul_f32 v167, v167, v29
    v_fma_f32 v168, v32, v76, v168
    v_fma_f32 v169, v32, v77, v169
    v_fma_f32 v170, v32, v78, v170
    v_fma_f32 v171, v32, v79, v171
    v_mul_f32 v168, v168, v33
    v_mul_f32 v169, v169, v33
    v_mul_f32 v170, v170, v33
    v_mul_f32 v171, v171, v33
    v_fma_f32 v172, v36, v76, v172
    v_fma_f32 v173, v36, v77, v173
    v_fma_f32 v174, v36, v78, v174
    v_fma_f32 v175, v36, v79, v175
    v_mul_f32 v172, v172, v37
    v_mul_f32 v173, v173, v37
    v_mul_f32 v174, v174, v37
    v_mul_f32 v175, v175, v37
    v_mov_b32_dpp v116, v164 row_ror:2 row_mask:0xf bank_mask:0xf
    v_mov_b32_dpp v117, v165 row_ror:2 row_mask:0xf bank_mask:0xf
    v_mov_b32_dpp v118, v166 row_ror:2 row_mask:0xf bank_mask:0xf
    v_mov_b32_dpp v119, v167 row_ror:2 row_mask:0xf bank_mask:0xf
    v_mov_b32_dpp v120, v168 row_ror:2 row_mask:0xf bank_mask:0xf
    v_mov_b32_dpp v121, v169 row_ror:2 row_mask:0xf bank_mask:0xf
    v_mov_b32_dpp v122, v170 row_ror:2 row_mask:0xf bank_mask:0xf
    v_mov_b32_dpp v123, v171 row_ror:2 row_mask:0xf bank_mask:0xf
    v_mov_b32_dpp v112, v164 row_shr:2 row_mask:0xf bank_mask:0xf
    v_mov_b32_dpp v113, v165 row_shr:2 row_mask:0xf bank_mask:0xf
    v_mov_b32_dpp v114, v166 row_shr:2 row_mask:0xf bank_mask:0xf
    v_mov_b32_dpp v115, v167 row_shr:2 row_mask:0xf bank_mask:0xf
    v_mov_b32_dpp v116, v168 row_shr:2 row_mask:0xf bank_mask:0xf
    v_mov_b32_dpp v117, v169 row_shr:2 row_mask:0xf bank_mask:0xf
    v_mov_b32_dpp v118, v170 row_shr:2 row_mask:0xf bank_mask:0xf
    v_mov_b32_dpp v119, v171 row_shr:2 row_mask:0xf bank_mask:0xf
    v_mov_b32_dpp v120, v172 row_shr:2 row_mask:0xf bank_mask:0xf
    v_mov_b32_dpp v121, v173 row_shr:2 row_mask:0xf bank_mask:0xf
    v_mov_b32_dpp v122, v174 row_shr:2 row_mask:0xf bank_mask:0xf
    v_mov_b32_dpp v123, v175 row_shr:2 row_mask:0xf bank_mask:0xf
    v_cvt_pk_bf16_f32 v164, v164, v112
    v_cvt_pk_bf16_f32 v165, v165, v113
    v_cvt_pk_bf16_f32 v166, v166, v114
    v_cvt_pk_bf16_f32 v167, v167, v115
    ds_write_b128 v241, v[164:167] offset:0
    v_cvt_pk_bf16_f32 v168, v168, v116
    v_cvt_pk_bf16_f32 v169, v169, v117
    v_cvt_pk_bf16_f32 v170, v170, v118
    v_cvt_pk_bf16_f32 v171, v171, v119
    ds_write_b128 v241, v[168:171] offset:1280
    v_cvt_pk_bf16_f32 v172, v172, v120
    v_cvt_pk_bf16_f32 v173, v173, v121
    v_cvt_pk_bf16_f32 v174, v174, v122
    v_cvt_pk_bf16_f32 v175, v175, v123
    ds_write_b128 v241, v[172:175] offset:2560
    v_fma_f32 v176, v28, v80, v176
    v_fma_f32 v177, v28, v81, v177
    v_fma_f32 v178, v28, v82, v178
    v_fma_f32 v179, v28, v83, v179
    v_mul_f32 v176, v176, v29
    v_mul_f32 v177, v177, v29
    v_mul_f32 v178, v178, v29
    v_mul_f32 v179, v179, v29
    v_fma_f32 v180, v32, v80, v180
    v_fma_f32 v181, v32, v81, v181
    v_fma_f32 v182, v32, v82, v182
    v_fma_f32 v183, v32, v83, v183
    v_mul_f32 v180, v180, v33
    v_mul_f32 v181, v181, v33
    v_mul_f32 v182, v182, v33
    v_mul_f32 v183, v183, v33
    v_fma_f32 v184, v36, v80, v184
    v_fma_f32 v185, v36, v81, v185
    v_fma_f32 v186, v36, v82, v186
    v_fma_f32 v187, v36, v83, v187
    v_mul_f32 v184, v184, v37
    v_mul_f32 v185, v185, v37
    v_mul_f32 v186, v186, v37
    v_mul_f32 v187, v187, v37
    v_mov_b32_dpp v116, v176 row_ror:2 row_mask:0xf bank_mask:0xf
    v_mov_b32_dpp v117, v177 row_ror:2 row_mask:0xf bank_mask:0xf
    v_mov_b32_dpp v118, v178 row_ror:2 row_mask:0xf bank_mask:0xf
    v_mov_b32_dpp v119, v179 row_ror:2 row_mask:0xf bank_mask:0xf
    v_mov_b32_dpp v120, v180 row_ror:2 row_mask:0xf bank_mask:0xf
    v_mov_b32_dpp v121, v181 row_ror:2 row_mask:0xf bank_mask:0xf
    v_mov_b32_dpp v122, v182 row_ror:2 row_mask:0xf bank_mask:0xf
    v_mov_b32_dpp v123, v183 row_ror:2 row_mask:0xf bank_mask:0xf
    v_mov_b32_dpp v112, v176 row_shr:2 row_mask:0xf bank_mask:0xf
    v_mov_b32_dpp v113, v177 row_shr:2 row_mask:0xf bank_mask:0xf
    v_mov_b32_dpp v114, v178 row_shr:2 row_mask:0xf bank_mask:0xf
    v_mov_b32_dpp v115, v179 row_shr:2 row_mask:0xf bank_mask:0xf
    v_mov_b32_dpp v116, v180 row_shr:2 row_mask:0xf bank_mask:0xf
    v_mov_b32_dpp v117, v181 row_shr:2 row_mask:0xf bank_mask:0xf
    v_mov_b32_dpp v118, v182 row_shr:2 row_mask:0xf bank_mask:0xf
    v_mov_b32_dpp v119, v183 row_shr:2 row_mask:0xf bank_mask:0xf
    v_mov_b32_dpp v120, v184 row_shr:2 row_mask:0xf bank_mask:0xf
    v_mov_b32_dpp v121, v185 row_shr:2 row_mask:0xf bank_mask:0xf
    v_mov_b32_dpp v122, v186 row_shr:2 row_mask:0xf bank_mask:0xf
    v_mov_b32_dpp v123, v187 row_shr:2 row_mask:0xf bank_mask:0xf
    v_cvt_pk_bf16_f32 v176, v176, v112
    v_cvt_pk_bf16_f32 v177, v177, v113
    v_cvt_pk_bf16_f32 v178, v178, v114
    v_cvt_pk_bf16_f32 v179, v179, v115
    ds_write_b128 v242, v[176:179] offset:0
    v_cvt_pk_bf16_f32 v180, v180, v116
    v_cvt_pk_bf16_f32 v181, v181, v117
    v_cvt_pk_bf16_f32 v182, v182, v118
    v_cvt_pk_bf16_f32 v183, v183, v119
    ds_write_b128 v242, v[180:183] offset:1280
    v_cvt_pk_bf16_f32 v184, v184, v120
    v_cvt_pk_bf16_f32 v185, v185, v121
    v_cvt_pk_bf16_f32 v186, v186, v122
    v_cvt_pk_bf16_f32 v187, v187, v123
    ds_write_b128 v242, v[184:187] offset:2560
    v_fma_f32 v188, v28, v84, v188
    v_fma_f32 v189, v28, v85, v189
    v_fma_f32 v190, v28, v86, v190
    v_fma_f32 v191, v28, v87, v191
    v_mul_f32 v188, v188, v29
    v_mul_f32 v189, v189, v29
    v_mul_f32 v190, v190, v29
    v_mul_f32 v191, v191, v29
    v_fma_f32 v192, v32, v84, v192
    v_fma_f32 v193, v32, v85, v193
    v_fma_f32 v194, v32, v86, v194
    v_fma_f32 v195, v32, v87, v195
    v_mul_f32 v192, v192, v33
    v_mul_f32 v193, v193, v33
    v_mul_f32 v194, v194, v33
    v_mul_f32 v195, v195, v33
    v_fma_f32 v196, v36, v84, v196
    v_fma_f32 v197, v36, v85, v197
    v_fma_f32 v198, v36, v86, v198
    v_fma_f32 v199, v36, v87, v199
    v_mul_f32 v196, v196, v37
    v_mul_f32 v197, v197, v37
    v_mul_f32 v198, v198, v37
    v_mul_f32 v199, v199, v37
    v_mov_b32_dpp v116, v188 row_ror:2 row_mask:0xf bank_mask:0xf
    v_mov_b32_dpp v117, v189 row_ror:2 row_mask:0xf bank_mask:0xf
    v_mov_b32_dpp v118, v190 row_ror:2 row_mask:0xf bank_mask:0xf
    v_mov_b32_dpp v119, v191 row_ror:2 row_mask:0xf bank_mask:0xf
    v_mov_b32_dpp v120, v192 row_ror:2 row_mask:0xf bank_mask:0xf
    v_mov_b32_dpp v121, v193 row_ror:2 row_mask:0xf bank_mask:0xf
    v_mov_b32_dpp v122, v194 row_ror:2 row_mask:0xf bank_mask:0xf
    v_mov_b32_dpp v123, v195 row_ror:2 row_mask:0xf bank_mask:0xf
    v_mov_b32_dpp v112, v188 row_shr:2 row_mask:0xf bank_mask:0xf
    v_mov_b32_dpp v113, v189 row_shr:2 row_mask:0xf bank_mask:0xf
    v_mov_b32_dpp v114, v190 row_shr:2 row_mask:0xf bank_mask:0xf
    v_mov_b32_dpp v115, v191 row_shr:2 row_mask:0xf bank_mask:0xf
    v_mov_b32_dpp v116, v192 row_shr:2 row_mask:0xf bank_mask:0xf
    v_mov_b32_dpp v117, v193 row_shr:2 row_mask:0xf bank_mask:0xf
    v_mov_b32_dpp v118, v194 row_shr:2 row_mask:0xf bank_mask:0xf
    v_mov_b32_dpp v119, v195 row_shr:2 row_mask:0xf bank_mask:0xf
    v_mov_b32_dpp v120, v196 row_shr:2 row_mask:0xf bank_mask:0xf
    v_mov_b32_dpp v121, v197 row_shr:2 row_mask:0xf bank_mask:0xf
    v_mov_b32_dpp v122, v198 row_shr:2 row_mask:0xf bank_mask:0xf
    v_mov_b32_dpp v123, v199 row_shr:2 row_mask:0xf bank_mask:0xf
    v_cvt_pk_bf16_f32 v188, v188, v112
    v_cvt_pk_bf16_f32 v189, v189, v113
    v_cvt_pk_bf16_f32 v190, v190, v114
    v_cvt_pk_bf16_f32 v191, v191, v115
    ds_write_b128 v243, v[188:191] offset:0
    v_cvt_pk_bf16_f32 v192, v192, v116
    v_cvt_pk_bf16_f32 v193, v193, v117
    v_cvt_pk_bf16_f32 v194, v194, v118
    v_cvt_pk_bf16_f32 v195, v195, v119
    ds_write_b128 v243, v[192:195] offset:1280
    v_cvt_pk_bf16_f32 v196, v196, v120
    v_cvt_pk_bf16_f32 v197, v197, v121
    v_cvt_pk_bf16_f32 v198, v198, v122
    v_cvt_pk_bf16_f32 v199, v199, v123
    ds_write_b128 v243, v[196:199] offset:2560
    v_fma_f32 v200, v28, v88, v200
    v_fma_f32 v201, v28, v89, v201
    v_fma_f32 v202, v28, v90, v202
    v_fma_f32 v203, v28, v91, v203
    v_mul_f32 v200, v200, v29
    v_mul_f32 v201, v201, v29
    v_mul_f32 v202, v202, v29
    v_mul_f32 v203, v203, v29
    v_fma_f32 v204, v32, v88, v204
    v_fma_f32 v205, v32, v89, v205
    v_fma_f32 v206, v32, v90, v206
    v_fma_f32 v207, v32, v91, v207
    v_mul_f32 v204, v204, v33
    v_mul_f32 v205, v205, v33
    v_mul_f32 v206, v206, v33
    v_mul_f32 v207, v207, v33
    v_fma_f32 v208, v36, v88, v208
    v_fma_f32 v209, v36, v89, v209
    v_fma_f32 v210, v36, v90, v210
    v_fma_f32 v211, v36, v91, v211
    v_mul_f32 v208, v208, v37
    v_mul_f32 v209, v209, v37
    v_mul_f32 v210, v210, v37
    v_mul_f32 v211, v211, v37
    v_mov_b32_dpp v116, v200 row_ror:2 row_mask:0xf bank_mask:0xf
    v_mov_b32_dpp v117, v201 row_ror:2 row_mask:0xf bank_mask:0xf
    v_mov_b32_dpp v118, v202 row_ror:2 row_mask:0xf bank_mask:0xf
    v_mov_b32_dpp v119, v203 row_ror:2 row_mask:0xf bank_mask:0xf
    v_mov_b32_dpp v120, v204 row_ror:2 row_mask:0xf bank_mask:0xf
    v_mov_b32_dpp v121, v205 row_ror:2 row_mask:0xf bank_mask:0xf
    v_mov_b32_dpp v122, v206 row_ror:2 row_mask:0xf bank_mask:0xf
    v_mov_b32_dpp v123, v207 row_ror:2 row_mask:0xf bank_mask:0xf
    v_mov_b32_dpp v112, v200 row_shr:2 row_mask:0xf bank_mask:0xf
    v_mov_b32_dpp v113, v201 row_shr:2 row_mask:0xf bank_mask:0xf
    v_mov_b32_dpp v114, v202 row_shr:2 row_mask:0xf bank_mask:0xf
    v_mov_b32_dpp v115, v203 row_shr:2 row_mask:0xf bank_mask:0xf
    v_mov_b32_dpp v116, v204 row_shr:2 row_mask:0xf bank_mask:0xf
    v_mov_b32_dpp v117, v205 row_shr:2 row_mask:0xf bank_mask:0xf
    v_mov_b32_dpp v118, v206 row_shr:2 row_mask:0xf bank_mask:0xf
    v_mov_b32_dpp v119, v207 row_shr:2 row_mask:0xf bank_mask:0xf
    v_mov_b32_dpp v120, v208 row_shr:2 row_mask:0xf bank_mask:0xf
    v_mov_b32_dpp v121, v209 row_shr:2 row_mask:0xf bank_mask:0xf
    v_mov_b32_dpp v122, v210 row_shr:2 row_mask:0xf bank_mask:0xf
    v_mov_b32_dpp v123, v211 row_shr:2 row_mask:0xf bank_mask:0xf
    v_cvt_pk_bf16_f32 v200, v200, v112
    v_cvt_pk_bf16_f32 v201, v201, v113
    v_cvt_pk_bf16_f32 v202, v202, v114
    v_cvt_pk_bf16_f32 v203, v203, v115
    ds_write_b128 v252, v[200:203] offset:0
    v_cvt_pk_bf16_f32 v204, v204, v116
    v_cvt_pk_bf16_f32 v205, v205, v117
    v_cvt_pk_bf16_f32 v206, v206, v118
    v_cvt_pk_bf16_f32 v207, v207, v119
    ds_write_b128 v252, v[204:207] offset:1280
    v_cvt_pk_bf16_f32 v208, v208, v120
    v_cvt_pk_bf16_f32 v209, v209, v121
    v_cvt_pk_bf16_f32 v210, v210, v122
    v_cvt_pk_bf16_f32 v211, v211, v123
    ds_write_b128 v252, v[208:211] offset:2560
    v_fma_f32 v212, v28, v92, v212
    v_fma_f32 v213, v28, v93, v213
    v_fma_f32 v214, v28, v94, v214
    v_fma_f32 v215, v28, v95, v215
    v_mul_f32 v212, v212, v29
    v_mul_f32 v213, v213, v29
    v_mul_f32 v214, v214, v29
    v_mul_f32 v215, v215, v29
    v_fma_f32 v216, v32, v92, v216
    v_fma_f32 v217, v32, v93, v217
    v_fma_f32 v218, v32, v94, v218
    v_fma_f32 v219, v32, v95, v219
    v_mul_f32 v216, v216, v33
    v_mul_f32 v217, v217, v33
    v_mul_f32 v218, v218, v33
    v_mul_f32 v219, v219, v33
    v_fma_f32 v220, v36, v92, v220
    v_fma_f32 v221, v36, v93, v221
    v_fma_f32 v222, v36, v94, v222
    v_fma_f32 v223, v36, v95, v223
    v_mul_f32 v220, v220, v37
    v_mul_f32 v221, v221, v37
    v_mul_f32 v222, v222, v37
    v_mul_f32 v223, v223, v37
    v_mov_b32_dpp v116, v212 row_ror:2 row_mask:0xf bank_mask:0xf
    v_mov_b32_dpp v117, v213 row_ror:2 row_mask:0xf bank_mask:0xf
    v_mov_b32_dpp v118, v214 row_ror:2 row_mask:0xf bank_mask:0xf
    v_mov_b32_dpp v119, v215 row_ror:2 row_mask:0xf bank_mask:0xf
    v_mov_b32_dpp v120, v216 row_ror:2 row_mask:0xf bank_mask:0xf
    v_mov_b32_dpp v121, v217 row_ror:2 row_mask:0xf bank_mask:0xf
    v_mov_b32_dpp v122, v218 row_ror:2 row_mask:0xf bank_mask:0xf
    v_mov_b32_dpp v123, v219 row_ror:2 row_mask:0xf bank_mask:0xf
    v_mov_b32_dpp v112, v212 row_shr:2 row_mask:0xf bank_mask:0xf
    v_mov_b32_dpp v113, v213 row_shr:2 row_mask:0xf bank_mask:0xf
    v_mov_b32_dpp v114, v214 row_shr:2 row_mask:0xf bank_mask:0xf
    v_mov_b32_dpp v115, v215 row_shr:2 row_mask:0xf bank_mask:0xf
    v_mov_b32_dpp v116, v216 row_shr:2 row_mask:0xf bank_mask:0xf
    v_mov_b32_dpp v117, v217 row_shr:2 row_mask:0xf bank_mask:0xf
    v_mov_b32_dpp v118, v218 row_shr:2 row_mask:0xf bank_mask:0xf
    v_mov_b32_dpp v119, v219 row_shr:2 row_mask:0xf bank_mask:0xf
    v_mov_b32_dpp v120, v220 row_shr:2 row_mask:0xf bank_mask:0xf
    v_mov_b32_dpp v121, v221 row_shr:2 row_mask:0xf bank_mask:0xf
    v_mov_b32_dpp v122, v222 row_shr:2 row_mask:0xf bank_mask:0xf
    v_mov_b32_dpp v123, v223 row_shr:2 row_mask:0xf bank_mask:0xf
    v_cvt_pk_bf16_f32 v212, v212, v112
    v_cvt_pk_bf16_f32 v213, v213, v113
    v_cvt_pk_bf16_f32 v214, v214, v114
    v_cvt_pk_bf16_f32 v215, v215, v115
    ds_write_b128 v13, v[212:215] offset:0
    v_cvt_pk_bf16_f32 v216, v216, v116
    v_cvt_pk_bf16_f32 v217, v217, v117
    v_cvt_pk_bf16_f32 v218, v218, v118
    v_cvt_pk_bf16_f32 v219, v219, v119
    ds_write_b128 v13, v[216:219] offset:1280
    v_cvt_pk_bf16_f32 v220, v220, v120
    v_cvt_pk_bf16_f32 v221, v221, v121
    v_cvt_pk_bf16_f32 v222, v222, v122
    v_cvt_pk_bf16_f32 v223, v223, v123
    ds_write_b128 v13, v[220:223] offset:2560
Q_ep_done:
    s_waitcnt lgkmcnt(0)
    s_barrier
    s_cmp_eq_u32 s40, 1
    s_cbranch_scc0 Q_nofix
    v_cmp_le_u32 vcc, 14, v18
    s_nop 1
    s_and_saveexec_b64 s[62:63], vcc
    ds_write_b16 v241, v172 offset:2722
    ds_write_b16 v241, v173 offset:2726
    ds_write_b16 v241, v174 offset:2730
    ds_write_b16 v241, v175 offset:2734
    ds_write_b16 v242, v184 offset:2722
    ds_write_b16 v242, v185 offset:2726
    ds_write_b16 v242, v186 offset:2730
    ds_write_b16 v242, v187 offset:2734
    ds_write_b16 v243, v196 offset:2722
    ds_write_b16 v243, v197 offset:2726
    ds_write_b16 v243, v198 offset:2730
    ds_write_b16 v243, v199 offset:2734
    ds_write_b16 v252, v208 offset:2722
    ds_write_b16 v252, v209 offset:2726
    ds_write_b16 v252, v210 offset:2730
    ds_write_b16 v252, v211 offset:2734
    ds_write_b16 v13, v220 offset:2722
    ds_write_b16 v13, v221 offset:2726
    ds_write_b16 v13, v222 offset:2730
    ds_write_b16 v13, v223 offset:2734
    s_mov_b64 exec, s[62:63]
    s_waitcnt lgkmcnt(0)
Q_nofix:
    s_barrier
    s_mov_b32 s59, s38
Q_att:
    s_mul_i32 s60, s59, 11
    s_lshr_b32 s60, s60, 5
    s_mul_i32 s51, s60, 3
    s_sub_u32 s61, s59, s51
    s_lshl_b32 s61, s61, 6
    v_add_u32 v14, s61, v0
    v_max_u32 v15, 14, v14
    v_add_u32 v16, s58, v14
    s_mul_i32 s51, s60, 9216
    v_mul_u32_u24 v17, 48, v15
    v_add_u32 v17, s51, v17
    v_add_u32 v18, 36192, v17
    s_mul_i32 s51, s60, 15520
    s_add_u32 s51, s51, 72768
    v_mul_u32_u24 v19, 80, v15
    v_add_u32 v19, s51, v19
    ds_read_b128 v[40:43], v17
    ds_read_b128 v[44:47], v17 offset:16
    ds_read_b64 v[48:49], v17 offset:32
    ds_read_b128 v[128:131], v18 offset:672
    ds_read_b128 v[132:135], v18 offset:688
    ds_read_b64 v[136:137], v18 offset:704
    ds_read_b128 v[138:141], v18 offset:576
    ds_read_b128 v[142:145], v18 offset:592
    ds_read_b64 v[146:147], v18 offset:608
    ds_read_b128 v[148:151], v18 offset:480
    ds_read_b128 v[152:155], v18 offset:496
    ds_read_b64 v[156:157], v18 offset:512
    ds_read_b128 v[158:161], v18 offset:384
    ds_read_b128 v[162:165], v18 offset:400
    ds_read_b64 v[166:167], v18 offset:416
    s_waitcnt lgkmcnt(0)
    v_dot2_f32_bf16 v50, v40, v128, 0
    v_dot2_f32_bf16 v51, v40, v138, 0
    v_dot2_f32_bf16 v52, v40, v148, 0
    v_dot2_f32_bf16 v53, v40, v158, 0
    v_dot2c_f32_bf16 v50, v41, v129
    v_dot2c_f32_bf16 v51, v41, v139
    v_dot2c_f32_bf16 v52, v41, v149
    v_dot2c_f32_bf16 v53, v41, v159
    v_dot2c_f32_bf16 v50, v42, v130
    v_dot2c_f32_bf16 v51, v42, v140
    v_dot2c_f32_bf16 v52, v42, v150
    v_dot2c_f32_bf16 v53, v42, v160
    v_dot2c_f32_bf16 v50, v43, v131
    v_dot2c_f32_bf16 v51, v43, v141
    v_dot2c_f32_bf16 v52, v43, v151
    v_dot2c_f32_bf16 v53, v43, v161
    v_dot2c_f32_bf16 v50, v44, v132
    v_dot2c_f32_bf16 v51, v44, v142
    v_dot2c_f32_bf16 v52, v44, v152
    v_dot2c_f32_bf16 v53, v44, v162
    v_dot2c_f32_bf16 v50, v45, v133
    v_dot2c_f32_bf16 v51, v45, v143
    v_dot2c_f32_bf16 v52, v45, v153
    v_dot2c_f32_bf16 v53, v45, v163
    v_dot2c_f32_bf16 v50, v46, v134
    v_dot2c_f32_bf16 v51, v46, v144
    v_dot2c_f32_bf16 v52, v46, v154
    v_dot2c_f32_bf16 v53, v46, v164
    v_dot2c_f32_bf16 v50, v47, v135
    v_dot2c_f32_bf16 v51, v47, v145
    v_dot2c_f32_bf16 v52, v47, v155
    v_dot2c_f32_bf16 v53, v47, v165
    v_dot2c_f32_bf16 v50, v48, v136
    v_dot2c_f32_bf16 v51, v48, v146
    v_dot2c_f32_bf16 v52, v48, v156
    v_dot2c_f32_bf16 v53, v48, v166
    v_dot2c_f32_bf16 v50, v49, v137
    v_dot2c_f32_bf16 v51, v49, v147
    v_dot2c_f32_bf16 v52, v49, v157
    v_dot2c_f32_bf16 v53, v49, v167
    ds_read_b128 v[168:171], v18 offset:288
    ds_read_b128 v[172:175], v18 offset:304
    ds_read_b64 v[176:177], v18 offset:320
    ds_read_b128 v[178:181], v18 offset:192
    ds_read_b128 v[182:185], v18 offset:208
    ds_read_b64 v[186:187], v18 offset:224
    ds_read_b128 v[188:191], v18 offset:96
    ds_read_b128 v[192:195], v18 offset:112
    ds_read_b64 v[196:197], v18 offset:128
    ds_read_b128 v[198:201], v18 offset:0
    ds_read_b128 v[202:205], v18 offset:16
    ds_read_b64 v[206:207], v18 offset:32
    s_waitcnt lgkmcnt(0)
    v_dot2_f32_bf16 v54, v40, v168, 0
    v_dot2_f32_bf16 v55, v40, v178, 0
    v_dot2_f32_bf16 v56, v40, v188, 0
    v_dot2_f32_bf16 v57, v40, v198, 0
    v_dot2c_f32_bf16 v54, v41, v169
    v_dot2c_f32_bf16 v55, v41, v179
    v_dot2c_f32_bf16 v56, v41, v189
    v_dot2c_f32_bf16 v57, v41, v199
    v_dot2c_f32_bf16 v54, v42, v170
    v_dot2c_f32_bf16 v55, v42, v180
    v_dot2c_f32_bf16 v56, v42, v190
    v_dot2c_f32_bf16 v57, v42, v200
    v_dot2c_f32_bf16 v54, v43, v171
    v_dot2c_f32_bf16 v55, v43, v181
    v_dot2c_f32_bf16 v56, v43, v191
    v_dot2c_f32_bf16 v57, v43, v201
    v_dot2c_f32_bf16 v54, v44, v172
    v_dot2c_f32_bf16 v55, v44, v182
    v_dot2c_f32_bf16 v56, v44, v192
    v_dot2c_f32_bf16 v57, v44, v202
    v_dot2c_f32_bf16 v54, v45, v173
    v_dot2c_f32_bf16 v55, v45, v183
    v_dot2c_f32_bf16 v56, v45, v193
    v_dot2c_f32_bf16 v57, v45, v203
    v_dot2c_f32_bf16 v54, v46, v174
    v_dot2c_f32_bf16 v55, v46, v184
    v_dot2c_f32_bf16 v56, v46, v194
    v_dot2c_f32_bf16 v57, v46, v204
    v_dot2c_f32_bf16 v54, v47, v175
    v_dot2c_f32_bf16 v55, v47, v185
    v_dot2c_f32_bf16 v56, v47, v195
    v_dot2c_f32_bf16 v57, v47, v205
    v_dot2c_f32_bf16 v54, v48, v176
    v_dot2c_f32_bf16 v55, v48, v186
    v_dot2c_f32_bf16 v56, v48, v196
    v_dot2c_f32_bf16 v57, v48, v206
    v_dot2c_f32_bf16 v54, v49, v177
    v_dot2c_f32_bf16 v55, v49, v187
    v_dot2c_f32_bf16 v56, v49, v197
    v_dot2c_f32_bf16 v57, v49, v207
    ds_read_b128 v[128:131], v19 offset:960
    ds_read_b128 v[132:135], v19 offset:976
    ds_read_b128 v[136:139], v19 offset:992
    ds_read_b128 v[140:143], v19 offset:1008
    ds_read_b128 v[144:147], v19 offset:1024
    ds_read_b128 v[148:151], v19 offset:640
    ds_read_b128 v[152:155], v19 offset:656
    ds_read_b128 v[156:159], v19 offset:672
    ds_read_b128 v[160:163], v19 offset:688
    ds_read_b128 v[164:167], v19 offset:704
    ds_read_b128 v[168:171], v19 offset:320
    ds_read_b128 v[172:175], v19 offset:336
    ds_read_b128 v[176:179], v19 offset:352
    ds_read_b128 v[180:183], v19 offset:368
    ds_read_b128 v[184:187], v19 offset:384
    ds_read_b128 v[188:191], v19 offset:0
    ds_read_b128 v[192:195], v19 offset:16
    ds_read_b128 v[196:199], v19 offset:32
    ds_read_b128 v[200:203], v19 offset:48
    ds_read_b128 v[204:207], v19 offset:64
    s_nop 2
    s_mov_b32 s51, 0xffff0000
    s_mov_b32 s55, 0x3e64f92e
    v_cvt_pk_bf16_f32 v60, v50, v51
    v_cvt_pk_bf16_f32 v61, v52, v53
    v_cvt_pk_bf16_f32 v62, v54, v55
    v_cvt_pk_bf16_f32 v63, v56, v57
    v_lshlrev_b32 v50, 16, v60
    v_and_b32 v51, s51, v60
    v_lshlrev_b32 v52, 16, v61
    v_and_b32 v53, s51, v61
    v_lshlrev_b32 v54, 16, v62
    v_and_b32 v55, s51, v62
    v_lshlrev_b32 v56, 16, v63
    v_and_b32 v57, s51, v63
    v_mul_f32 v50, s55, v50
    v_mul_f32 v51, s55, v51
    v_mul_f32 v52, s55, v52
    v_mul_f32 v53, s55, v53
    v_mul_f32 v54, s55, v54
    v_mul_f32 v55, s55, v55
    v_mul_f32 v56, s55, v56
    v_mul_f32 v57, s55, v57
    v_cvt_pk_bf16_f32 v60, v50, v51
    v_cvt_pk_bf16_f32 v61, v52, v53
    v_cvt_pk_bf16_f32 v62, v54, v55
    v_cvt_pk_bf16_f32 v63, v56, v57
    v_lshlrev_b32 v50, 16, v60
    v_and_b32 v51, s51, v60
    v_lshlrev_b32 v52, 16, v61
    v_and_b32 v53, s51, v61
    v_lshlrev_b32 v54, 16, v62
    v_and_b32 v55, s51, v62
    v_lshlrev_b32 v56, 16, v63
    v_and_b32 v57, s51, v63
    s_cmp_eq_u32 s36, 0
    s_cbranch_scc0 Q_nomask
    v_mov_b32 v64, 0xce6e6b28
    v_cmp_gt_i32 vcc, 2, v16
    s_nop 1
    v_cndmask_b32 v51, v51, v64, vcc
    v_cmp_gt_i32 vcc, 4, v16
    s_nop 1
    v_cndmask_b32 v52, v52, v64, vcc
    v_cmp_gt_i32 vcc, 6, v16
    s_nop 1
    v_cndmask_b32 v53, v53, v64, vcc
    v_cmp_gt_i32 vcc, 8, v16
    s_nop 1
    v_cndmask_b32 v54, v54, v64, vcc
    v_cmp_gt_i32 vcc, 10, v16
    s_nop 1
    v_cndmask_b32 v55, v55, v64, vcc
    v_cmp_gt_i32 vcc, 12, v16
    s_nop 1
    v_cndmask_b32 v56, v56, v64, vcc
    v_cmp_gt_i32 vcc, 14, v16
    s_nop 1
    v_cndmask_b32 v57, v57, v64, vcc
Q_nomask:
    v_max3_f32 v64, v50, v51, v52
    v_max3_f32 v65, v53, v54, v55
    v_max3_f32 v64, v64, v56, v57
    v_max_f32 v64, v64, v65
    s_mov_b32 s55, 0x3fb8aa3b
    v_mul_f32 v64, s55, v64
    v_fma_f32 v50, v50, s55, -v64
    v_fma_f32 v51, v51, s55, -v64
    v_fma_f32 v52, v52, s55, -v64
    v_fma_f32 v53, v53, s55, -v64
    v_fma_f32 v54, v54, s55, -v64
    v_fma_f32 v55, v55, s55, -v64
    v_fma_f32 v56, v56, s55, -v64
    v_fma_f32 v57, v57, s55, -v64
    v_exp_f32 v50, v50
    v_exp_f32 v51, v51
    v_exp_f32 v52, v52
    v_exp_f32 v53, v53
    v_exp_f32 v54, v54
    v_exp_f32 v55, v55
    v_exp_f32 v56, v56
    v_exp_f32 v57, v57
    s_nop 0
    v_add_f32 v64, v50, v51
    v_add_f32 v65, v52, v53
    v_add_f32 v66, v54, v55
    v_add_f32 v67, v56, v57
    v_add_f32 v64, v64, v65
    v_add_f32 v66, v66, v67
    v_add_f32 v64, v64, v66
    v_rcp_f32 v64, v64
    s_nop 0
    v_mul_f32 v50, v50, v64
    v_mul_f32 v51, v51, v64
    v_mul_f32 v52, v52, v64
    v_mul_f32 v53, v53, v64
    v_mul_f32 v54, v54, v64
    v_mul_f32 v55, v55, v64
    v_mul_f32 v56, v56, v64
    v_mul_f32 v57, v57, v64
    v_cvt_pk_bf16_f32 v60, v50, v51
    v_cvt_pk_bf16_f32 v61, v52, v53
    v_cvt_pk_bf16_f32 v62, v54, v55
    v_cvt_pk_bf16_f32 v63, v56, v57
    s_waitcnt lgkmcnt(0)
    v_dot2_f32_bf16 v70, v128, v60, 0
    v_dot2_f32_bf16 v71, v129, v60, 0
    v_dot2_f32_bf16 v72, v130, v60, 0
    v_dot2_f32_bf16 v73, v131, v60, 0
    v_dot2_f32_bf16 v74, v132, v60, 0
    v_dot2_f32_bf16 v75, v133, v60, 0
    v_dot2_f32_bf16 v76, v134, v60, 0
    v_dot2_f32_bf16 v77, v135, v60, 0
    v_dot2_f32_bf16 v78, v136, v60, 0
    v_dot2_f32_bf16 v79, v137, v60, 0
    v_dot2_f32_bf16 v80, v138, v60, 0
    v_dot2_f32_bf16 v81, v139, v60, 0
    v_dot2_f32_bf16 v82, v140, v60, 0
    v_dot2_f32_bf16 v83, v141, v60, 0
    v_dot2_f32_bf16 v84, v142, v60, 0
    v_dot2_f32_bf16 v85, v143, v60, 0
    v_dot2_f32_bf16 v86, v144, v60, 0
    v_dot2_f32_bf16 v87, v145, v60, 0
    v_dot2_f32_bf16 v88, v146, v60, 0
    v_dot2_f32_bf16 v89, v147, v60, 0
    v_dot2c_f32_bf16 v70, v148, v61
    v_dot2c_f32_bf16 v71, v149, v61
    v_dot2c_f32_bf16 v72, v150, v61
    v_dot2c_f32_bf16 v73, v151, v61
    v_dot2c_f32_bf16 v74, v152, v61
    v_dot2c_f32_bf16 v75, v153, v61
    v_dot2c_f32_bf16 v76, v154, v61
    v_dot2c_f32_bf16 v77, v155, v61
    v_dot2c_f32_bf16 v78, v156, v61
    v_dot2c_f32_bf16 v79, v157, v61
    v_dot2c_f32_bf16 v80, v158, v61
    v_dot2c_f32_bf16 v81, v159, v61
    v_dot2c_f32_bf16 v82, v160, v61
    v_dot2c_f32_bf16 v83, v161, v61
    v_dot2c_f32_bf16 v84, v162, v61
    v_dot2c_f32_bf16 v85, v163, v61
    v_dot2c_f32_bf16 v86, v164, v61
    v_dot2c_f32_bf16 v87, v165, v61
    v_dot2c_f32_bf16 v88, v166, v61
    v_dot2c_f32_bf16 v89, v167, v61
    v_dot2c_f32_bf16 v70, v168, v62
    v_dot2c_f32_bf16 v71, v169, v62
    v_dot2c_f32_bf16 v72, v170, v62
    v_dot2c_f32_bf16 v73, v171, v62
    v_dot2c_f32_bf16 v74, v172, v62
    v_dot2c_f32_bf16 v75, v173, v62
    v_dot2c_f32_bf16 v76, v174, v62
    v_dot2c_f32_bf16 v77, v175, v62
    v_dot2c_f32_bf16 v78, v176, v62
    v_dot2c_f32_bf16 v79, v177, v62
    v_dot2c_f32_bf16 v80, v178, v62
    v_dot2c_f32_bf16 v81, v179, v62
    v_dot2c_f32_bf16 v82, v180, v62
    v_dot2c_f32_bf16 v83, v181, v62
    v_dot2c_f32_bf16 v84, v182, v62
    v_dot2c_f32_bf16 v85, v183, v62
    v_dot2c_f32_bf16 v86, v184, v62
    v_dot2c_f32_bf16 v87, v185, v62
    v_dot2c_f32_bf16 v88, v186, v62
    v_dot2c_f32_bf16 v89, v187, v62
    v_dot2c_f32_bf16 v70, v188, v63
    v_dot2c_f32_bf16 v71, v189, v63
    v_dot2c_f32_bf16 v72, v190, v63
    v_dot2c_f32_bf16 v73, v191, v63
    v_dot2c_f32_bf16 v74, v192, v63
    v_dot2c_f32_bf16 v75, v193, v63
    v_dot2c_f32_bf16 v76, v194, v63
    v_dot2c_f32_bf16 v77, v195, v63
    v_dot2c_f32_bf16 v78, v196, v63
    v_dot2c_f32_bf16 v79, v197, v63
    v_dot2c_f32_bf16 v80, v198, v63
    v_dot2c_f32_bf16 v81, v199, v63
    v_dot2c_f32_bf16 v82, v200, v63
    v_dot2c_f32_bf16 v83, v201, v63
    v_dot2c_f32_bf16 v84, v202, v63
    v_dot2c_f32_bf16 v85, v203, v63
    v_dot2c_f32_bf16 v86, v204, v63
    v_dot2c_f32_bf16 v87, v205, v63
    v_dot2c_f32_bf16 v88, v206, v63
    v_dot2c_f32_bf16 v89, v207, v63
    s_nop 2
    v_cvt_pk_bf16_f32 v100, v70, v71
    v_cvt_pk_bf16_f32 v101, v72, v73
    v_cvt_pk_bf16_f32 v102, v74, v75
    v_cvt_pk_bf16_f32 v103, v76, v77
    v_cvt_pk_bf16_f32 v104, v78, v79
    v_cvt_pk_bf16_f32 v105, v80, v81
    v_cvt_pk_bf16_f32 v106, v82, v83
    v_cvt_pk_bf16_f32 v107, v84, v85
    v_cvt_pk_bf16_f32 v108, v86, v87
    v_cvt_pk_bf16_f32 v109, v88, v89
    v_lshrrev_b32 v20, 4, v16
    v_lshlrev_b32 v20, 10, v20
    v_and_b32 v21, 15, v16
    v_lshl_add_u32 v20, v21, 4, v20
    v_cmp_le_u32 s[62:63], 14, v14
    v_cmp_gt_i32 vcc, 0x800, v16
    s_lshl_b32 s51, s37, 2
    s_add_u32 s51, s51, s60
    s_mul_i32 s51, s51, 20
    s_and_b64 vcc, vcc, s[62:63]
    s_and_saveexec_b64 s[62:63], vcc
    s_cbranch_execz Q_nostore
    s_add_u32 s55, s51, 0
    s_lshr_b32 s56, s55, 5
    s_lshl_b32 s56, s56, 17
    s_bfe_u32 s57, s55, 0x20002
    s_lshl_b32 s57, s57, 8
    s_add_u32 s56, s56, s57
    s_bfe_u32 s57, s55, 0x10004
    s_lshl_b32 s57, s57, 3
    s_add_u32 s56, s56, s57
    buffer_store_dwordx2 v[100:101], v20, s[20:23], s56 offen
    s_add_u32 s55, s51, 4
    s_lshr_b32 s56, s55, 5
    s_lshl_b32 s56, s56, 17
    s_bfe_u32 s57, s55, 0x20002
    s_lshl_b32 s57, s57, 8
    s_add_u32 s56, s56, s57
    s_bfe_u32 s57, s55, 0x10004
    s_lshl_b32 s57, s57, 3
    s_add_u32 s56, s56, s57
    buffer_store_dwordx2 v[102:103], v20, s[20:23], s56 offen
    s_add_u32 s55, s51, 8
    s_lshr_b32 s56, s55, 5
    s_lshl_b32 s56, s56, 17
    s_bfe_u32 s57, s55, 0x20002
    s_lshl_b32 s57, s57, 8
    s_add_u32 s56, s56, s57
    s_bfe_u32 s57, s55, 0x10004
    s_lshl_b32 s57, s57, 3
    s_add_u32 s56, s56, s57
    buffer_store_dwordx2 v[104:105], v20, s[20:23], s56 offen
    s_add_u32 s55, s51, 12
    s_lshr_b32 s56, s55, 5
    s_lshl_b32 s56, s56, 17
    s_bfe_u32 s57, s55, 0x20002
    s_lshl_b32 s57, s57, 8
    s_add_u32 s56, s56, s57
    s_bfe_u32 s57, s55, 0x10004
    s_lshl_b32 s57, s57, 3
    s_add_u32 s56, s56, s57
    buffer_store_dwordx2 v[106:107], v20, s[20:23], s56 offen
    s_add_u32 s55, s51, 16
    s_lshr_b32 s56, s55, 5
    s_lshl_b32 s56, s56, 17
    s_bfe_u32 s57, s55, 0x20002
    s_lshl_b32 s57, s57, 8
    s_add_u32 s56, s56, s57
    s_bfe_u32 s57, s55, 0x10004
    s_lshl_b32 s57, s57, 3
    s_add_u32 s56, s56, s57
    buffer_store_dwordx2 v[108:109], v20, s[20:23], s56 offen
Q_nostore:
    s_mov_b64 exec, s[62:63]
    s_add_u32 s59, s59, 8
    s_cmp_lt_u32 s59, 12
    s_cbranch_scc1 Q_att
K1_end:
    s_endpgm
K1_helper:
    s_load_dwordx2 s[6:7], s[0:1], 16
    s_load_dwordx2 s[28:29], s[0:1], 48
    s_lshr_b32 s36, s34, 1
    s_lshl_b32 s36, s36, 2
    s_add_u32 s36, s36, s35
    s_sub_u32 s36, s36, 28
    v_lshlrev_b32 v1, 4, v0
    s_mul_i32 s51, s38, 5120
    v_add_u32 v1, s51, v1
    v_add_u32 v2, 0x1000, v1
    v_lshrrev_b32 v10, 4, v0
    v_and_b32 v11, 15, v0
    v_lshrrev_b32 v12, 2, v11
    v_lshl_add_u32 v12, v10, 2, v12
    v_mul_u32_u24 v12, 1280, v12
    v_and_b32 v13, 3, v11
    v_lshlrev_b32 v13, 3, v13
    s_mul_i32 s55, s38, 160
    v_add3_u32 v7, v12, v13, s55
    s_waitcnt lgkmcnt(0)
    s_mov_b32 s76, s24
    s_mov_b32 s77, s25
    s_mov_b32 s78, s26
    s_mov_b32 s79, s27
    s_mov_b32 s12, s6
    s_and_b32 s13, s7, 0xffff
    s_mov_b32 s14, 819200
    s_mov_b32 s15, 0x00020000
    s_mov_b32 s16, s28
    s_and_b32 s17, s29, 0xffff
    s_mov_b32 s18, 2211840
    s_mov_b32 s19, 0x00020000
    s_add_u32 s24, s32, 9699328
    s_addc_u32 s25, s33, 0
    s_and_b32 s25, s25, 0xffff
    s_mov_b32 s26, 3031040
    s_mov_b32 s27, 0x00020000
    s_mul_i32 s43, s38, 5120
    v_add_u32 v8, 81920, v7
    s_lshl_b32 s51, s36, 7
    s_lshl_b32 s55, s38, 4
    s_add_u32 s51, s51, s55
    v_lshrrev_b32 v14, 2, v0
    v_add_u32 v14, s51, v14
    v_mul_u32_u24 v15, 1280, v14
    v_and_b32 v16, 3, v0
    v_lshl_add_u32 v15, v16, 4, v15
    s_add_u32 s44, s32, 12730368
    s_addc_u32 s45, s33, 0
    s_and_b32 s45, s45, 0xffff
    s_mov_b32 s46, 65536
    s_mov_b32 s47, 0x00020000
    s_mov_b32 s55, 0xffff0000
    v_mov_b32 v20, 0
    v_mov_b32 v21, 0
    v_mov_b32 v22, 0
    v_mov_b32 v23, 0
    buffer_load_dwordx4 v[140:143], v15, s[8:11], 0 offen offset:0
    buffer_load_dwordx4 v[144:147], v15, s[8:11], 0 offen offset:64
    buffer_load_dwordx4 v[148:151], v15, s[8:11], 0 offen offset:128
    buffer_load_dwordx4 v[152:155], v15, s[8:11], 0 offen offset:192
    buffer_load_dwordx4 v[156:159], v15, s[8:11], 0 offen offset:256
    buffer_load_dwordx4 v[160:163], v15, s[8:11], 0 offen offset:320
    buffer_load_dwordx4 v[164:167], v15, s[8:11], 0 offen offset:384
    buffer_load_dwordx4 v[168:171], v15, s[8:11], 0 offen offset:448
    buffer_load_dwordx4 v[172:175], v15, s[8:11], 0 offen offset:512
    buffer_load_dwordx4 v[176:179], v15, s[8:11], 0 offen offset:576
    buffer_load_dwordx4 v[180:183], v15, s[8:11], 0 offen offset:640
    buffer_load_dwordx4 v[184:187], v15, s[8:11], 0 offen offset:704
    buffer_load_dwordx4 v[188:191], v15, s[8:11], 0 offen offset:768
    buffer_load_dwordx4 v[192:195], v15, s[8:11], 0 offen offset:832
    buffer_load_dwordx4 v[196:199], v15, s[8:11], 0 offen offset:896
    buffer_load_dwordx4 v[200:203], v15, s[8:11], 0 offen offset:960
    buffer_load_dwordx4 v[204:207], v15, s[8:11], 0 offen offset:1024
    buffer_load_dwordx4 v[208:211], v15, s[8:11], 0 offen offset:1088
    buffer_load_dwordx4 v[212:215], v15, s[8:11], 0 offen offset:1152
    buffer_load_dwordx4 v[216:219], v15, s[8:11], 0 offen offset:1216
    s_waitcnt vmcnt(19)
    v_lshlrev_b32 v24, 16, v140
    v_and_b32 v25, s55, v140
    v_lshlrev_b32 v26, 16, v141
    v_and_b32 v27, s55, v141
    v_lshlrev_b32 v28, 16, v142
    v_and_b32 v29, s55, v142
    v_lshlrev_b32 v30, 16, v143
    v_and_b32 v31, s55, v143
    v_add_f32 v20, v20, v24
    v_fmac_f32 v21, v24, v24
    v_add_f32 v22, v22, v25
    v_fmac_f32 v23, v25, v25
    v_add_f32 v20, v20, v26
    v_fmac_f32 v21, v26, v26
    v_add_f32 v22, v22, v27
    v_fmac_f32 v23, v27, v27
    v_add_f32 v20, v20, v28
    v_fmac_f32 v21, v28, v28
    v_add_f32 v22, v22, v29
    v_fmac_f32 v23, v29, v29
    v_add_f32 v20, v20, v30
    v_fmac_f32 v21, v30, v30
    v_add_f32 v22, v22, v31
    v_fmac_f32 v23, v31, v31
    s_waitcnt vmcnt(18)
    v_lshlrev_b32 v24, 16, v144
    v_and_b32 v25, s55, v144
    v_lshlrev_b32 v26, 16, v145
    v_and_b32 v27, s55, v145
    v_lshlrev_b32 v28, 16, v146
    v_and_b32 v29, s55, v146
    v_lshlrev_b32 v30, 16, v147
    v_and_b32 v31, s55, v147
    v_add_f32 v20, v20, v24
    v_fmac_f32 v21, v24, v24
    v_add_f32 v22, v22, v25
    v_fmac_f32 v23, v25, v25
    v_add_f32 v20, v20, v26
    v_fmac_f32 v21, v26, v26
    v_add_f32 v22, v22, v27
    v_fmac_f32 v23, v27, v27
    v_add_f32 v20, v20, v28
    v_fmac_f32 v21, v28, v28
    v_add_f32 v22, v22, v29
    v_fmac_f32 v23, v29, v29
    v_add_f32 v20, v20, v30
    v_fmac_f32 v21, v30, v30
    v_add_f32 v22, v22, v31
    v_fmac_f32 v23, v31, v31
    s_waitcnt vmcnt(17)
    v_lshlrev_b32 v24, 16, v148
    v_and_b32 v25, s55, v148
    v_lshlrev_b32 v26, 16, v149
    v_and_b32 v27, s55, v149
    v_lshlrev_b32 v28, 16, v150
    v_and_b32 v29, s55, v150
    v_lshlrev_b32 v30, 16, v151
    v_and_b32 v31, s55, v151
    v_add_f32 v20, v20, v24
    v_fmac_f32 v21, v24, v24
    v_add_f32 v22, v22, v25
    v_fmac_f32 v23, v25, v25
    v_add_f32 v20, v20, v26
    v_fmac_f32 v21, v26, v26
    v_add_f32 v22, v22, v27
    v_fmac_f32 v23, v27, v27
    v_add_f32 v20, v20, v28
    v_fmac_f32 v21, v28, v28
    v_add_f32 v22, v22, v29
    v_fmac_f32 v23, v29, v29
    v_add_f32 v20, v20, v30
    v_fmac_f32 v21, v30, v30
    v_add_f32 v22, v22, v31
    v_fmac_f32 v23, v31, v31
    s_waitcnt vmcnt(16)
    v_lshlrev_b32 v24, 16, v152
    v_and_b32 v25, s55, v152
    v_lshlrev_b32 v26, 16, v153
    v_and_b32 v27, s55, v153
    v_lshlrev_b32 v28, 16, v154
    v_and_b32 v29, s55, v154
    v_lshlrev_b32 v30, 16, v155
    v_and_b32 v31, s55, v155
    v_add_f32 v20, v20, v24
    v_fmac_f32 v21, v24, v24
    v_add_f32 v22, v22, v25
    v_fmac_f32 v23, v25, v25
    v_add_f32 v20, v20, v26
    v_fmac_f32 v21, v26, v26
    v_add_f32 v22, v22, v27
    v_fmac_f32 v23, v27, v27
    v_add_f32 v20, v20, v28
    v_fmac_f32 v21, v28, v28
    v_add_f32 v22, v22, v29
    v_fmac_f32 v23, v29, v29
    v_add_f32 v20, v20, v30
    v_fmac_f32 v21, v30, v30
    v_add_f32 v22, v22, v31
    v_fmac_f32 v23, v31, v31
    s_waitcnt vmcnt(15)
    v_lshlrev_b32 v24, 16, v156
    v_and_b32 v25, s55, v156
    v_lshlrev_b32 v26, 16, v157
    v_and_b32 v27, s55, v157
    v_lshlrev_b32 v28, 16, v158
    v_and_b32 v29, s55, v158
    v_lshlrev_b32 v30, 16, v159
    v_and_b32 v31, s55, v159
    v_add_f32 v20, v20, v24
    v_fmac_f32 v21, v24, v24
    v_add_f32 v22, v22, v25
    v_fmac_f32 v23, v25, v25
    v_add_f32 v20, v20, v26
    v_fmac_f32 v21, v26, v26
    v_add_f32 v22, v22, v27
    v_fmac_f32 v23, v27, v27
    v_add_f32 v20, v20, v28
    v_fmac_f32 v21, v28, v28
    v_add_f32 v22, v22, v29
    v_fmac_f32 v23, v29, v29
    v_add_f32 v20, v20, v30
    v_fmac_f32 v21, v30, v30
    v_add_f32 v22, v22, v31
    v_fmac_f32 v23, v31, v31
    s_waitcnt vmcnt(14)
    v_lshlrev_b32 v24, 16, v160
    v_and_b32 v25, s55, v160
    v_lshlrev_b32 v26, 16, v161
    v_and_b32 v27, s55, v161
    v_lshlrev_b32 v28, 16, v162
    v_and_b32 v29, s55, v162
    v_lshlrev_b32 v30, 16, v163
    v_and_b32 v31, s55, v163
    v_add_f32 v20, v20, v24
    v_fmac_f32 v21, v24, v24
    v_add_f32 v22, v22, v25
    v_fmac_f32 v23, v25, v25
    v_add_f32 v20, v20, v26
    v_fmac_f32 v21, v26, v26
    v_add_f32 v22, v22, v27
    v_fmac_f32 v23, v27, v27
    v_add_f32 v20, v20, v28
    v_fmac_f32 v21, v28, v28
    v_add_f32 v22, v22, v29
    v_fmac_f32 v23, v29, v29
    v_add_f32 v20, v20, v30
    v_fmac_f32 v21, v30, v30
    v_add_f32 v22, v22, v31
    v_fmac_f32 v23, v31, v31
    s_waitcnt vmcnt(13)
    v_lshlrev_b32 v24, 16, v164
    v_and_b32 v25, s55, v164
    v_lshlrev_b32 v26, 16, v165
    v_and_b32 v27, s55, v165
    v_lshlrev_b32 v28, 16, v166
    v_and_b32 v29, s55, v166
    v_lshlrev_b32 v30, 16, v167
    v_and_b32 v31, s55, v167
    v_add_f32 v20, v20, v24
    v_fmac_f32 v21, v24, v24
    v_add_f32 v22, v22, v25
    v_fmac_f32 v23, v25, v25
    v_add_f32 v20, v20, v26
    v_fmac_f32 v21, v26, v26
    v_add_f32 v22, v22, v27
    v_fmac_f32 v23, v27, v27
    v_add_f32 v20, v20, v28
    v_fmac_f32 v21, v28, v28
    v_add_f32 v22, v22, v29
    v_fmac_f32 v23, v29, v29
    v_add_f32 v20, v20, v30
    v_fmac_f32 v21, v30, v30
    v_add_f32 v22, v22, v31
    v_fmac_f32 v23, v31, v31
    s_waitcnt vmcnt(12)
    v_lshlrev_b32 v24, 16, v168
    v_and_b32 v25, s55, v168
    v_lshlrev_b32 v26, 16, v169
    v_and_b32 v27, s55, v169
    v_lshlrev_b32 v28, 16, v170
    v_and_b32 v29, s55, v170
    v_lshlrev_b32 v30, 16, v171
    v_and_b32 v31, s55, v171
    v_add_f32 v20, v20, v24
    v_fmac_f32 v21, v24, v24
    v_add_f32 v22, v22, v25
    v_fmac_f32 v23, v25, v25
    v_add_f32 v20, v20, v26
    v_fmac_f32 v21, v26, v26
    v_add_f32 v22, v22, v27
    v_fmac_f32 v23, v27, v27
    v_add_f32 v20, v20, v28
    v_fmac_f32 v21, v28, v28
    v_add_f32 v22, v22, v29
    v_fmac_f32 v23, v29, v29
    v_add_f32 v20, v20, v30
    v_fmac_f32 v21, v30, v30
    v_add_f32 v22, v22, v31
    v_fmac_f32 v23, v31, v31
    s_waitcnt vmcnt(11)
    v_lshlrev_b32 v24, 16, v172
    v_and_b32 v25, s55, v172
    v_lshlrev_b32 v26, 16, v173
    v_and_b32 v27, s55, v173
    v_lshlrev_b32 v28, 16, v174
    v_and_b32 v29, s55, v174
    v_lshlrev_b32 v30, 16, v175
    v_and_b32 v31, s55, v175
    v_add_f32 v20, v20, v24
    v_fmac_f32 v21, v24, v24
    v_add_f32 v22, v22, v25
    v_fmac_f32 v23, v25, v25
    v_add_f32 v20, v20, v26
    v_fmac_f32 v21, v26, v26
    v_add_f32 v22, v22, v27
    v_fmac_f32 v23, v27, v27
    v_add_f32 v20, v20, v28
    v_fmac_f32 v21, v28, v28
    v_add_f32 v22, v22, v29
    v_fmac_f32 v23, v29, v29
    v_add_f32 v20, v20, v30
    v_fmac_f32 v21, v30, v30
    v_add_f32 v22, v22, v31
    v_fmac_f32 v23, v31, v31
    s_waitcnt vmcnt(10)
    v_lshlrev_b32 v24, 16, v176
    v_and_b32 v25, s55, v176
    v_lshlrev_b32 v26, 16, v177
    v_and_b32 v27, s55, v177
    v_lshlrev_b32 v28, 16, v178
    v_and_b32 v29, s55, v178
    v_lshlrev_b32 v30, 16, v179
    v_and_b32 v31, s55, v179
    v_add_f32 v20, v20, v24
    v_fmac_f32 v21, v24, v24
    v_add_f32 v22, v22, v25
    v_fmac_f32 v23, v25, v25
    v_add_f32 v20, v20, v26
    v_fmac_f32 v21, v26, v26
    v_add_f32 v22, v22, v27
    v_fmac_f32 v23, v27, v27
    v_add_f32 v20, v20, v28
    v_fmac_f32 v21, v28, v28
    v_add_f32 v22, v22, v29
    v_fmac_f32 v23, v29, v29
    v_add_f32 v20, v20, v30
    v_fmac_f32 v21, v30, v30
    v_add_f32 v22, v22, v31
    v_fmac_f32 v23, v31, v31
    s_waitcnt vmcnt(9)
    v_lshlrev_b32 v24, 16, v180
    v_and_b32 v25, s55, v180
    v_lshlrev_b32 v26, 16, v181
    v_and_b32 v27, s55, v181
    v_lshlrev_b32 v28, 16, v182
    v_and_b32 v29, s55, v182
    v_lshlrev_b32 v30, 16, v183
    v_and_b32 v31, s55, v183
    v_add_f32 v20, v20, v24
    v_fmac_f32 v21, v24, v24
    v_add_f32 v22, v22, v25
    v_fmac_f32 v23, v25, v25
    v_add_f32 v20, v20, v26
    v_fmac_f32 v21, v26, v26
    v_add_f32 v22, v22, v27
    v_fmac_f32 v23, v27, v27
    v_add_f32 v20, v20, v28
    v_fmac_f32 v21, v28, v28
    v_add_f32 v22, v22, v29
    v_fmac_f32 v23, v29, v29
    v_add_f32 v20, v20, v30
    v_fmac_f32 v21, v30, v30
    v_add_f32 v22, v22, v31
    v_fmac_f32 v23, v31, v31
    s_waitcnt vmcnt(8)
    v_lshlrev_b32 v24, 16, v184
    v_and_b32 v25, s55, v184
    v_lshlrev_b32 v26, 16, v185
    v_and_b32 v27, s55, v185
    v_lshlrev_b32 v28, 16, v186
    v_and_b32 v29, s55, v186
    v_lshlrev_b32 v30, 16, v187
    v_and_b32 v31, s55, v187
    v_add_f32 v20, v20, v24
    v_fmac_f32 v21, v24, v24
    v_add_f32 v22, v22, v25
    v_fmac_f32 v23, v25, v25
    v_add_f32 v20, v20, v26
    v_fmac_f32 v21, v26, v26
    v_add_f32 v22, v22, v27
    v_fmac_f32 v23, v27, v27
    v_add_f32 v20, v20, v28
    v_fmac_f32 v21, v28, v28
    v_add_f32 v22, v22, v29
    v_fmac_f32 v23, v29, v29
    v_add_f32 v20, v20, v30
    v_fmac_f32 v21, v30, v30
    v_add_f32 v22, v22, v31
    v_fmac_f32 v23, v31, v31
    s_waitcnt vmcnt(7)
    v_lshlrev_b32 v24, 16, v188
    v_and_b32 v25, s55, v188
    v_lshlrev_b32 v26, 16, v189
    v_and_b32 v27, s55, v189
    v_lshlrev_b32 v28, 16, v190
    v_and_b32 v29, s55, v190
    v_lshlrev_b32 v30, 16, v191
    v_and_b32 v31, s55, v191
    v_add_f32 v20, v20, v24
    v_fmac_f32 v21, v24, v24
    v_add_f32 v22, v22, v25
    v_fmac_f32 v23, v25, v25
    v_add_f32 v20, v20, v26
    v_fmac_f32 v21, v26, v26
    v_add_f32 v22, v22, v27
    v_fmac_f32 v23, v27, v27
    v_add_f32 v20, v20, v28
    v_fmac_f32 v21, v28, v28
    v_add_f32 v22, v22, v29
    v_fmac_f32 v23, v29, v29
    v_add_f32 v20, v20, v30
    v_fmac_f32 v21, v30, v30
    v_add_f32 v22, v22, v31
    v_fmac_f32 v23, v31, v31
    s_waitcnt vmcnt(6)
    v_lshlrev_b32 v24, 16, v192
    v_and_b32 v25, s55, v192
    v_lshlrev_b32 v26, 16, v193
    v_and_b32 v27, s55, v193
    v_lshlrev_b32 v28, 16, v194
    v_and_b32 v29, s55, v194
    v_lshlrev_b32 v30, 16, v195
    v_and_b32 v31, s55, v195
    v_add_f32 v20, v20, v24
    v_fmac_f32 v21, v24, v24
    v_add_f32 v22, v22, v25
    v_fmac_f32 v23, v25, v25
    v_add_f32 v20, v20, v26
    v_fmac_f32 v21, v26, v26
    v_add_f32 v22, v22, v27
    v_fmac_f32 v23, v27, v27
    v_add_f32 v20, v20, v28
    v_fmac_f32 v21, v28, v28
    v_add_f32 v22, v22, v29
    v_fmac_f32 v23, v29, v29
    v_add_f32 v20, v20, v30
    v_fmac_f32 v21, v30, v30
    v_add_f32 v22, v22, v31
    v_fmac_f32 v23, v31, v31
    s_waitcnt vmcnt(5)
    v_lshlrev_b32 v24, 16, v196
    v_and_b32 v25, s55, v196
    v_lshlrev_b32 v26, 16, v197
    v_and_b32 v27, s55, v197
    v_lshlrev_b32 v28, 16, v198
    v_and_b32 v29, s55, v198
    v_lshlrev_b32 v30, 16, v199
    v_and_b32 v31, s55, v199
    v_add_f32 v20, v20, v24
    v_fmac_f32 v21, v24, v24
    v_add_f32 v22, v22, v25
    v_fmac_f32 v23, v25, v25
    v_add_f32 v20, v20, v26
    v_fmac_f32 v21, v26, v26
    v_add_f32 v22, v22, v27
    v_fmac_f32 v23, v27, v27
    v_add_f32 v20, v20, v28
    v_fmac_f32 v21, v28, v28
    v_add_f32 v22, v22, v29
    v_fmac_f32 v23, v29, v29
    v_add_f32 v20, v20, v30
    v_fmac_f32 v21, v30, v30
    v_add_f32 v22, v22, v31
    v_fmac_f32 v23, v31, v31
    s_waitcnt vmcnt(4)
    v_lshlrev_b32 v24, 16, v200
    v_and_b32 v25, s55, v200
    v_lshlrev_b32 v26, 16, v201
    v_and_b32 v27, s55, v201
    v_lshlrev_b32 v28, 16, v202
    v_and_b32 v29, s55, v202
    v_lshlrev_b32 v30, 16, v203
    v_and_b32 v31, s55, v203
    v_add_f32 v20, v20, v24
    v_fmac_f32 v21, v24, v24
    v_add_f32 v22, v22, v25
    v_fmac_f32 v23, v25, v25
    v_add_f32 v20, v20, v26
    v_fmac_f32 v21, v26, v26
    v_add_f32 v22, v22, v27
    v_fmac_f32 v23, v27, v27
    v_add_f32 v20, v20, v28
    v_fmac_f32 v21, v28, v28
    v_add_f32 v22, v22, v29
    v_fmac_f32 v23, v29, v29
    v_add_f32 v20, v20, v30
    v_fmac_f32 v21, v30, v30
    v_add_f32 v22, v22, v31
    v_fmac_f32 v23, v31, v31
    s_waitcnt vmcnt(3)
    v_lshlrev_b32 v24, 16, v204
    v_and_b32 v25, s55, v204
    v_lshlrev_b32 v26, 16, v205
    v_and_b32 v27, s55, v205
    v_lshlrev_b32 v28, 16, v206
    v_and_b32 v29, s55, v206
    v_lshlrev_b32 v30, 16, v207
    v_and_b32 v31, s55, v207
    v_add_f32 v20, v20, v24
    v_fmac_f32 v21, v24, v24
    v_add_f32 v22, v22, v25
    v_fmac_f32 v23, v25, v25
    v_add_f32 v20, v20, v26
    v_fmac_f32 v21, v26, v26
    v_add_f32 v22, v22, v27
    v_fmac_f32 v23, v27, v27
    v_add_f32 v20, v20, v28
    v_fmac_f32 v21, v28, v28
    v_add_f32 v22, v22, v29
    v_fmac_f32 v23, v29, v29
    v_add_f32 v20, v20, v30
    v_fmac_f32 v21, v30, v30
    v_add_f32 v22, v22, v31
    v_fmac_f32 v23, v31, v31
    s_waitcnt vmcnt(2)
    v_lshlrev_b32 v24, 16, v208
    v_and_b32 v25, s55, v208
    v_lshlrev_b32 v26, 16, v209
    v_and_b32 v27, s55, v209
    v_lshlrev_b32 v28, 16, v210
    v_and_b32 v29, s55, v210
    v_lshlrev_b32 v30, 16, v211
    v_and_b32 v31, s55, v211
    v_add_f32 v20, v20, v24
    v_fmac_f32 v21, v24, v24
    v_add_f32 v22, v22, v25
    v_fmac_f32 v23, v25, v25
    v_add_f32 v20, v20, v26
    v_fmac_f32 v21, v26, v26
    v_add_f32 v22, v22, v27
    v_fmac_f32 v23, v27, v27
    v_add_f32 v20, v20, v28
    v_fmac_f32 v21, v28, v28
    v_add_f32 v22, v22, v29
    v_fmac_f32 v23, v29, v29
    v_add_f32 v20, v20, v30
    v_fmac_f32 v21, v30, v30
    v_add_f32 v22, v22, v31
    v_fmac_f32 v23, v31, v31
    s_waitcnt vmcnt(1)
    v_lshlrev_b32 v24, 16, v212
    v_and_b32 v25, s55, v212
    v_lshlrev_b32 v26, 16, v213
    v_and_b32 v27, s55, v213
    v_lshlrev_b32 v28, 16, v214
    v_and_b32 v29, s55, v214
    v_lshlrev_b32 v30, 16, v215
    v_and_b32 v31, s55, v215
    v_add_f32 v20, v20, v24
    v_fmac_f32 v21, v24, v24
    v_add_f32 v22, v22, v25
    v_fmac_f32 v23, v25, v25
    v_add_f32 v20, v20, v26
    v_fmac_f32 v21, v26, v26
    v_add_f32 v22, v22, v27
    v_fmac_f32 v23, v27, v27
    v_add_f32 v20, v20, v28
    v_fmac_f32 v21, v28, v28
    v_add_f32 v22, v22, v29
    v_fmac_f32 v23, v29, v29
    v_add_f32 v20, v20, v30
    v_fmac_f32 v21, v30, v30
    v_add_f32 v22, v22, v31
    v_fmac_f32 v23, v31, v31
    s_waitcnt vmcnt(0)
    v_lshlrev_b32 v24, 16, v216
    v_and_b32 v25, s55, v216
    v_lshlrev_b32 v26, 16, v217
    v_and_b32 v27, s55, v217
    v_lshlrev_b32 v28, 16, v218
    v_and_b32 v29, s55, v218
    v_lshlrev_b32 v30, 16, v219
    v_and_b32 v31, s55, v219
    v_add_f32 v20, v20, v24
    v_fmac_f32 v21, v24, v24
    v_add_f32 v22, v22, v25
    v_fmac_f32 v23, v25, v25
    v_add_f32 v20, v20, v26
    v_fmac_f32 v21, v26, v26
    v_add_f32 v22, v22, v27
    v_fmac_f32 v23, v27, v27
    v_add_f32 v20, v20, v28
    v_fmac_f32 v21, v28, v28
    v_add_f32 v22, v22, v29
    v_fmac_f32 v23, v29, v29
    v_add_f32 v20, v20, v30
    v_fmac_f32 v21, v30, v30
    v_add_f32 v22, v22, v31
    v_fmac_f32 v23, v31, v31
    v_add_f32 v20, v20, v22
    v_add_f32 v21, v21, v23
    s_nop 1
    v_add_f32_dpp v20, v20, v20 quad_perm:[1,0,3,2] row_mask:0xf bank_mask:0xf
    v_add_f32_dpp v21, v21, v21 quad_perm:[1,0,3,2] row_mask:0xf bank_mask:0xf
    s_nop 1
    v_add_f32_dpp v20, v20, v20 quad_perm:[2,3,0,1] row_mask:0xf bank_mask:0xf
    v_add_f32_dpp v21, v21, v21 quad_perm:[2,3,0,1] row_mask:0xf bank_mask:0xf
    v_mul_f32 v20, 0x3acccccd, v20
    v_mul_f32 v21, 0x3acccccd, v21
    v_fma_f32 v21, -v20, v20, v21
    v_max_f32 v21, 0, v21
    v_cvt_pk_bf16_f32 v20, v20, v20
    v_lshlrev_b32 v20, 16, v20
    v_cvt_pk_bf16_f32 v21, v21, v21
    v_lshlrev_b32 v21, 16, v21
    v_add_f32 v21, 0x3727c5ac, v21
    v_cvt_pk_bf16_f32 v21, v21, v21
    v_lshlrev_b32 v21, 16, v21
    v_sqrt_f32 v21, v21
    s_nop 0
    v_cvt_pk_bf16_f32 v21, v21, v21
    v_lshlrev_b32 v21, 16, v21
    v_rcp_f32 v22, v21
    v_sub_f32 v32, 0, v20
    v_mul_f32 v35, v21, v21
    v_mul_f32 v33, 0xc0135761, v22
    v_mul_f32 v23, v22, v22
    v_mul_f32 v23, v23, v22
    v_mul_f32 v34, 0xbdd2d3e8, v23
    v_mov_b32 v36, v32
    v_mov_b32 v37, v22
    v_mov_b32 v38, 0
    v_mov_b32 v39, 0
    v_lshlrev_b32 v14, 5, v14
    v_cmp_eq_u32 vcc, 0, v16
    s_nop 1
    s_and_saveexec_b64 s[62:63], vcc
    buffer_store_dwordx4 v[32:35], v14, s[44:47], 0 offen sc1
    buffer_store_dwordx4 v[36:39], v14, s[44:47], 0 offen offset:16 sc1
    s_mov_b64 exec, s[62:63]
    s_waitcnt vmcnt(0)
    s_barrier
    s_cmp_eq_u32 s38, 0
    s_cbranch_scc0 H_nosig
    v_mov_b32 v14, 0
    v_mov_b32 v15, 1
    s_mov_b64 exec, 1
    buffer_atomic_add v15, v14, s[76:79], 0 offen sc1
    s_mov_b64 exec, -1
H_nosig:
    s_add_u32 s59, s36, 0
    s_cmp_lt_u32 s59, 20
    s_cselect_b32 s48, s12, s16
    s_cselect_b32 s49, s13, s17
    s_cselect_b32 s50, s14, s18
    s_mov_b32 s51, 0x00020000
    s_cselect_b32 s42, 0, 20
    s_sub_u32 s42, s59, s42
    s_mul_i32 s42, s42, 40960
    s_add_u32 m0, s43, 0
    s_nop 0
    buffer_load_dwordx4 v1, s[48:51], s42 offen offset:0 lds
    buffer_load_dwordx4 v1, s[48:51], s42 offen offset:1024 lds
    buffer_load_dwordx4 v1, s[48:51], s42 offen offset:2048 lds
    buffer_load_dwordx4 v1, s[48:51], s42 offen offset:3072 lds
    s_add_u32 m0, s43, 4096
    s_nop 0
    buffer_load_dwordx4 v2, s[48:51], s42 offen lds
    s_add_u32 s59, s36, 16
    s_cmp_lt_u32 s59, 20
    s_cselect_b32 s48, s12, s16
    s_cselect_b32 s49, s13, s17
    s_cselect_b32 s50, s14, s18
    s_mov_b32 s51, 0x00020000
    s_cselect_b32 s42, 0, 20
    s_sub_u32 s42, s59, s42
    s_mul_i32 s42, s42, 40960
    s_add_u32 m0, s43, 40960
    s_nop 0
    buffer_load_dwordx4 v1, s[48:51], s42 offen offset:0 lds
    buffer_load_dwordx4 v1, s[48:51], s42 offen offset:1024 lds
    buffer_load_dwordx4 v1, s[48:51], s42 offen offset:2048 lds
    buffer_load_dwordx4 v1, s[48:51], s42 offen offset:3072 lds
    s_add_u32 m0, s43, 45056
    s_nop 0
    buffer_load_dwordx4 v2, s[48:51], s42 offen lds
    s_add_u32 s59, s36, 32
    s_cmp_lt_u32 s59, 20
    s_cselect_b32 s48, s12, s16
    s_cselect_b32 s49, s13, s17
    s_cselect_b32 s50, s14, s18
    s_mov_b32 s51, 0x00020000
    s_cselect_b32 s42, 0, 20
    s_sub_u32 s42, s59, s42
    s_mul_i32 s42, s42, 40960
    s_add_u32 m0, s43, 81920
    s_nop 0
    buffer_load_dwordx4 v1, s[48:51], s42 offen offset:0 lds
    buffer_load_dwordx4 v1, s[48:51], s42 offen offset:1024 lds
    buffer_load_dwordx4 v1, s[48:51], s42 offen offset:2048 lds
    buffer_load_dwordx4 v1, s[48:51], s42 offen offset:3072 lds
    s_add_u32 m0, s43, 86016
    s_nop 0
    buffer_load_dwordx4 v2, s[48:51], s42 offen lds
    s_add_u32 s59, s36, 48
    s_cmp_lt_u32 s59, 20
    s_cselect_b32 s48, s12, s16
    s_cselect_b32 s49, s13, s17
    s_cselect_b32 s50, s14, s18
    s_mov_b32 s51, 0x00020000
    s_cselect_b32 s42, 0, 20
    s_sub_u32 s42, s59, s42
    s_mul_i32 s42, s42, 40960
    s_add_u32 m0, s43, 122880
    s_nop 0
    buffer_load_dwordx4 v1, s[48:51], s42 offen offset:0 lds
    buffer_load_dwordx4 v1, s[48:51], s42 offen offset:1024 lds
    buffer_load_dwordx4 v1, s[48:51], s42 offen offset:2048 lds
    buffer_load_dwordx4 v1, s[48:51], s42 offen offset:3072 lds
    s_add_u32 m0, s43, 126976
    s_nop 0
    buffer_load_dwordx4 v2, s[48:51], s42 offen lds
    s_waitcnt vmcnt(15)
    s_barrier
    ds_read_b64_tr_b16 v[20:21], v7 offset:0
    ds_read_b64_tr_b16 v[22:23], v7 offset:20480
    ds_read_b64_tr_b16 v[24:25], v7 offset:32
    ds_read_b64_tr_b16 v[26:27], v7 offset:20512
    ds_read_b64_tr_b16 v[28:29], v7 offset:64
    ds_read_b64_tr_b16 v[30:31], v7 offset:20544
    ds_read_b64_tr_b16 v[32:33], v7 offset:96
    ds_read_b64_tr_b16 v[34:35], v7 offset:20576
    ds_read_b64_tr_b16 v[36:37], v7 offset:128
    ds_read_b64_tr_b16 v[38:39], v7 offset:20608
    s_add_u32 s59, s36, 0
    s_mul_i32 s42, s59, 40960
    s_waitcnt lgkmcnt(0)
    buffer_store_dwordx4 v[20:23], v1, s[24:27], s42 offen offset:0 sc1
    buffer_store_dwordx4 v[24:27], v1, s[24:27], s42 offen offset:1024 sc1
    buffer_store_dwordx4 v[28:31], v1, s[24:27], s42 offen offset:2048 sc1
    buffer_store_dwordx4 v[32:35], v1, s[24:27], s42 offen offset:3072 sc1
    buffer_store_dwordx4 v[36:39], v2, s[24:27], s42 offen sc1
    s_barrier
    s_add_u32 s59, s36, 64
    s_cmp_lt_u32 s59, 20
    s_cselect_b32 s48, s12, s16
    s_cselect_b32 s49, s13, s17
    s_cselect_b32 s50, s14, s18
    s_mov_b32 s51, 0x00020000
    s_cselect_b32 s42, 0, 20
    s_sub_u32 s42, s59, s42
    s_mul_i32 s42, s42, 40960
    s_add_u32 m0, s43, 0
    s_nop 0
    buffer_load_dwordx4 v1, s[48:51], s42 offen offset:0 lds
    buffer_load_dwordx4 v1, s[48:51], s42 offen offset:1024 lds
    buffer_load_dwordx4 v1, s[48:51], s42 offen offset:2048 lds
    buffer_load_dwordx4 v1, s[48:51], s42 offen offset:3072 lds
    s_add_u32 m0, s43, 4096
    s_nop 0
    buffer_load_dwordx4 v2, s[48:51], s42 offen lds
    s_waitcnt vmcnt(20)
    s_barrier
    ds_read_b64_tr_b16 v[40:41], v7 offset:40960
    ds_read_b64_tr_b16 v[42:43], v7 offset:61440
    ds_read_b64_tr_b16 v[44:45], v7 offset:40992
    ds_read_b64_tr_b16 v[46:47], v7 offset:61472
    ds_read_b64_tr_b16 v[48:49], v7 offset:41024
    ds_read_b64_tr_b16 v[50:51], v7 offset:61504
    ds_read_b64_tr_b16 v[52:53], v7 offset:41056
    ds_read_b64_tr_b16 v[54:55], v7 offset:61536
    ds_read_b64_tr_b16 v[56:57], v7 offset:41088
    ds_read_b64_tr_b16 v[58:59], v7 offset:61568
    s_add_u32 s59, s36, 16
    s_mul_i32 s42, s59, 40960
    s_waitcnt lgkmcnt(0)
    buffer_store_dwordx4 v[40:43], v1, s[24:27], s42 offen offset:0 sc1
    buffer_store_dwordx4 v[44:47], v1, s[24:27], s42 offen offset:1024 sc1
    buffer_store_dwordx4 v[48:51], v1, s[24:27], s42 offen offset:2048 sc1
    buffer_store_dwordx4 v[52:55], v1, s[24:27], s42 offen offset:3072 sc1
    buffer_store_dwordx4 v[56:59], v2, s[24:27], s42 offen sc1
    s_waitcnt vmcnt(20)
    s_barrier
    ds_read_b64_tr_b16 v[60:61], v8 offset:0
    ds_read_b64_tr_b16 v[62:63], v8 offset:20480
    ds_read_b64_tr_b16 v[64:65], v8 offset:32
    ds_read_b64_tr_b16 v[66:67], v8 offset:20512
    ds_read_b64_tr_b16 v[68:69], v8 offset:64
    ds_read_b64_tr_b16 v[70:71], v8 offset:20544
    ds_read_b64_tr_b16 v[72:73], v8 offset:96
    ds_read_b64_tr_b16 v[74:75], v8 offset:20576
    ds_read_b64_tr_b16 v[76:77], v8 offset:128
    ds_read_b64_tr_b16 v[78:79], v8 offset:20608
    s_add_u32 s59, s36, 32
    s_mul_i32 s42, s59, 40960
    s_waitcnt lgkmcnt(0)
    buffer_store_dwordx4 v[60:63], v1, s[24:27], s42 offen offset:0 sc1
    buffer_store_dwordx4 v[64:67], v1, s[24:27], s42 offen offset:1024 sc1
    buffer_store_dwordx4 v[68:71], v1, s[24:27], s42 offen offset:2048 sc1
    buffer_store_dwordx4 v[72:75], v1, s[24:27], s42 offen offset:3072 sc1
    buffer_store_dwordx4 v[76:79], v2, s[24:27], s42 offen sc1
    s_waitcnt vmcnt(20)
    s_barrier
    ds_read_b64_tr_b16 v[80:81], v8 offset:40960
    ds_read_b64_tr_b16 v[82:83], v8 offset:61440
    ds_read_b64_tr_b16 v[84:85], v8 offset:40992
    ds_read_b64_tr_b16 v[86:87], v8 offset:61472
    ds_read_b64_tr_b16 v[88:89], v8 offset:41024
    ds_read_b64_tr_b16 v[90:91], v8 offset:61504
    ds_read_b64_tr_b16 v[92:93], v8 offset:41056
    ds_read_b64_tr_b16 v[94:95], v8 offset:61536
    ds_read_b64_tr_b16 v[96:97], v8 offset:41088
    ds_read_b64_tr_b16 v[98:99], v8 offset:61568
    s_add_u32 s59, s36, 48
    s_mul_i32 s42, s59, 40960
    s_waitcnt lgkmcnt(0)
    buffer_store_dwordx4 v[80:83], v1, s[24:27], s42 offen offset:0 sc1
    buffer_store_dwordx4 v[84:87], v1, s[24:27], s42 offen offset:1024 sc1
    buffer_store_dwordx4 v[88:91], v1, s[24:27], s42 offen offset:2048 sc1
    buffer_store_dwordx4 v[92:95], v1, s[24:27], s42 offen offset:3072 sc1
    buffer_store_dwordx4 v[96:99], v2, s[24:27], s42 offen sc1
    s_waitcnt vmcnt(15)
    s_barrier
    ds_read_b64_tr_b16 v[100:101], v7 offset:0
    ds_read_b64_tr_b16 v[102:103], v7 offset:20480
    ds_read_b64_tr_b16 v[104:105], v7 offset:32
    ds_read_b64_tr_b16 v[106:107], v7 offset:20512
    ds_read_b64_tr_b16 v[108:109], v7 offset:64
    ds_read_b64_tr_b16 v[110:111], v7 offset:20544
    ds_read_b64_tr_b16 v[112:113], v7 offset:96
    ds_read_b64_tr_b16 v[114:115], v7 offset:20576
    ds_read_b64_tr_b16 v[116:117], v7 offset:128
    ds_read_b64_tr_b16 v[118:119], v7 offset:20608
    s_add_u32 s59, s36, 64
    s_mul_i32 s42, s59, 40960
    s_waitcnt lgkmcnt(0)
    buffer_store_dwordx4 v[100:103], v1, s[24:27], s42 offen offset:0 sc1
    buffer_store_dwordx4 v[104:107], v1, s[24:27], s42 offen offset:1024 sc1
    buffer_store_dwordx4 v[108:111], v1, s[24:27], s42 offen offset:2048 sc1
    buffer_store_dwordx4 v[112:115], v1, s[24:27], s42 offen offset:3072 sc1
    buffer_store_dwordx4 v[116:119], v2, s[24:27], s42 offen sc1
    s_endpgm
    .p2align 8
    .globl k2_kernel
    .type k2_kernel,@function
k2_kernel:
    s_cmp_ge_u32 s2, 256
    s_cbranch_scc1 K2_end
    s_load_dwordx2 s[4:5], s[0:1], 0
    s_load_dwordx2 s[30:31], s[0:1], 56
    s_load_dwordx2 s[32:33], s[0:1], 72
    s_and_b32 s34, s2, 7
    s_lshr_b32 s35, s2, 3
    s_lshr_b32 s36, s35, 3
    s_lshl_b32 s37, s34, 2
    s_add_u32 s36, s36, s37
    s_and_b32 s37, s35, 7
    v_lshrrev_b32 v1, 6, v0
    v_and_b32 v0, 63, v0
    s_nop 0
    v_readfirstlane_b32 s38, v1
    s_mul_i32 s39, s37, 160
    s_lshl_b32 s55, s38, 17
    s_mul_i32 s43, s38, 40960
    s_lshl_b32 s44, s36, 12
    v_lshlrev_b32 v1, 4, v0
    s_mul_i32 s45, s37, 5120
    v_add_u32 v2, s45, v1
    v_add_u32 v3, 0x1000, v2
    v_add_u32 v1, s44, v1
    v_lshrrev_b32 v10, 4, v0
    v_and_b32 v11, 15, v0
    s_lshl_b32 s45, s36, 6
    s_lshl_b32 s46, s38, 4
    s_add_u32 s45, s45, s46
    v_add_u32 v12, s45, v11
    v_mul_u32_u24 v12, 1280, v12
    v_lshlrev_b32 v13, 3, v10
    v_add3_u32 v8, v12, v13, s39
    s_mul_i32 s46, s38, 20480
    v_lshlrev_b32 v9, 4, v0
    v_add_u32 v9, s46, v9
    s_lshl_b32 s46, s38, 10
    v_lshlrev_b32 v20, 4, v0
    v_add_u32 v20, s46, v20
    v_add_u32 v21, 40960, v20
    s_mul_i32 s52, s35, 1
    s_mul_i32 s54, s52, 65537
    s_lshr_b32 s54, s54, 16
    s_mul_i32 s54, s54, 1
    s_sub_u32 s52, s52, s54
    s_add_u32 s56, s55, 0
    s_add_u32 s57, s43, 0
    s_mul_i32 s54, s52, 524288
    s_add_u32 s40, s56, s54
    s_mul_i32 s54, s52, 163840
    s_add_u32 s42, s57, s54
    s_waitcnt lgkmcnt(0)
    s_mov_b32 s8, s32
    s_and_b32 s9, s33, 0xffff
    s_mov_b32 s10, 9699328
    s_mov_b32 s11, 0x00020000
    s_add_u32 s12, s32, 9699328
    s_addc_u32 s13, s33, 0
    s_and_b32 s13, s13, 0xffff
    s_mov_b32 s14, 3031040
    s_mov_b32 s15, 0x00020000
    s_mov_b32 s20, s4
    s_and_b32 s21, s5, 0xffff
    s_mov_b32 s22, 2621440
    s_mov_b32 s23, 0x00020000
    s_mov_b32 s24, s30
    s_and_b32 s25, s31, 0xffff
    s_mov_b32 s26, 2621440
    s_mov_b32 s27, 0x00020000
    buffer_load_dwordx4 v[48:51], v2, s[12:15], s42 offen offset:0
    buffer_load_dwordx4 v[52:55], v2, s[12:15], s42 offen offset:1024
    buffer_load_dwordx4 v[56:59], v2, s[12:15], s42 offen offset:2048
    buffer_load_dwordx4 v[60:63], v2, s[12:15], s42 offen offset:3072
    buffer_load_dwordx4 v[64:67], v3, s[12:15], s42 offen
    buffer_load_dwordx4 v[32:35], v1, s[8:11], s40 offen offset:0
    buffer_load_dwordx4 v[36:39], v1, s[8:11], s40 offen offset:1024
    buffer_load_dwordx4 v[40:43], v1, s[8:11], s40 offen offset:2048
    buffer_load_dwordx4 v[44:47], v1, s[8:11], s40 offen offset:3072
    s_mul_i32 s52, s35, 1
    s_mul_i32 s54, s52, 65537
    s_lshr_b32 s54, s54, 16
    s_mul_i32 s54, s54, 1
    s_sub_u32 s52, s52, s54
    s_add_u32 s56, s55, 524288
    s_add_u32 s57, s43, 163840
    s_mul_i32 s54, s52, 524288
    s_add_u32 s40, s56, s54
    s_mul_i32 s54, s52, 163840
    s_add_u32 s42, s57, s54
    buffer_load_dwordx4 v[84:87], v2, s[12:15], s42 offen offset:0
    buffer_load_dwordx4 v[88:91], v2, s[12:15], s42 offen offset:1024
    buffer_load_dwordx4 v[92:95], v2, s[12:15], s42 offen offset:2048
    buffer_load_dwordx4 v[96:99], v2, s[12:15], s42 offen offset:3072
    buffer_load_dwordx4 v[100:103], v3, s[12:15], s42 offen
    buffer_load_dwordx4 v[68:71], v1, s[8:11], s40 offen offset:0
    buffer_load_dwordx4 v[72:75], v1, s[8:11], s40 offen offset:1024
    buffer_load_dwordx4 v[76:79], v1, s[8:11], s40 offen offset:2048
    buffer_load_dwordx4 v[80:83], v1, s[8:11], s40 offen offset:3072
    s_mul_i32 s52, s35, 1
    s_mul_i32 s54, s52, 65537
    s_lshr_b32 s54, s54, 16
    s_mul_i32 s54, s54, 1
    s_sub_u32 s52, s52, s54
    s_add_u32 s56, s55, 1048576
    s_add_u32 s57, s43, 327680
    s_mul_i32 s54, s52, 524288
    s_add_u32 s40, s56, s54
    s_mul_i32 s54, s52, 163840
    s_add_u32 s42, s57, s54
    buffer_load_dwordx4 v[120:123], v2, s[12:15], s42 offen offset:0
    buffer_load_dwordx4 v[124:127], v2, s[12:15], s42 offen offset:1024
    buffer_load_dwordx4 v[128:131], v2, s[12:15], s42 offen offset:2048
    buffer_load_dwordx4 v[132:135], v2, s[12:15], s42 offen offset:3072
    buffer_load_dwordx4 v[136:139], v3, s[12:15], s42 offen
    buffer_load_dwordx4 v[104:107], v1, s[8:11], s40 offen offset:0
    buffer_load_dwordx4 v[108:111], v1, s[8:11], s40 offen offset:1024
    buffer_load_dwordx4 v[112:115], v1, s[8:11], s40 offen offset:2048
    buffer_load_dwordx4 v[116:119], v1, s[8:11], s40 offen offset:3072
    s_mul_i32 s52, s35, 1
    s_mul_i32 s54, s52, 65537
    s_lshr_b32 s54, s54, 16
    s_mul_i32 s54, s54, 1
    s_sub_u32 s52, s52, s54
    s_add_u32 s56, s55, 1572864
    s_add_u32 s57, s43, 491520
    s_mul_i32 s54, s52, 524288
    s_add_u32 s40, s56, s54
    s_mul_i32 s54, s52, 163840
    s_add_u32 s42, s57, s54
    buffer_load_dwordx4 v[156:159], v2, s[12:15], s42 offen offset:0
    buffer_load_dwordx4 v[160:163], v2, s[12:15], s42 offen offset:1024
    buffer_load_dwordx4 v[164:167], v2, s[12:15], s42 offen offset:2048
    buffer_load_dwordx4 v[168:171], v2, s[12:15], s42 offen offset:3072
    buffer_load_dwordx4 v[172:175], v3, s[12:15], s42 offen
    buffer_load_dwordx4 v[140:143], v1, s[8:11], s40 offen offset:0
    buffer_load_dwordx4 v[144:147], v1, s[8:11], s40 offen offset:1024
    buffer_load_dwordx4 v[148:151], v1, s[8:11], s40 offen offset:2048
    buffer_load_dwordx4 v[152:155], v1, s[8:11], s40 offen offset:3072
    s_mul_i32 s52, s35, 1
    s_mul_i32 s54, s52, 65537
    s_lshr_b32 s54, s54, 16
    s_mul_i32 s54, s54, 1
    s_sub_u32 s52, s52, s54
    s_add_u32 s56, s55, 2097152
    s_add_u32 s57, s43, 655360
    s_mul_i32 s54, s52, 524288
    s_add_u32 s40, s56, s54
    s_mul_i32 s54, s52, 163840
    s_add_u32 s42, s57, s54
    buffer_load_dwordx4 v[192:195], v2, s[12:15], s42 offen offset:0
    buffer_load_dwordx4 v[196:199], v2, s[12:15], s42 offen offset:1024
    buffer_load_dwordx4 v[200:203], v2, s[12:15], s42 offen offset:2048
    buffer_load_dwordx4 v[204:207], v2, s[12:15], s42 offen offset:3072
    buffer_load_dwordx4 v[208:211], v3, s[12:15], s42 offen
    buffer_load_dwordx4 v[176:179], v1, s[8:11], s40 offen offset:0
    buffer_load_dwordx4 v[180:183], v1, s[8:11], s40 offen offset:1024
    buffer_load_dwordx4 v[184:187], v1, s[8:11], s40 offen offset:2048
    buffer_load_dwordx4 v[188:191], v1, s[8:11], s40 offen offset:3072
    s_mul_i32 s52, s35, 1
    s_mul_i32 s54, s52, 65537
    s_lshr_b32 s54, s54, 16
    s_mul_i32 s54, s54, 1
    s_sub_u32 s52, s52, s54
    s_add_u32 s56, s55, 2621440
    s_add_u32 s57, s43, 819200
    s_mul_i32 s54, s52, 524288
    s_add_u32 s40, s56, s54
    s_mul_i32 s54, s52, 163840
    s_add_u32 s42, s57, s54
    s_waitcnt vmcnt(36)
    v_mfma_f32_16x16x32_bf16 a[0:3], v[48:51], v[32:35], 0
    v_mfma_f32_16x16x32_bf16 a[4:7], v[48:51], v[36:39], 0
    v_mfma_f32_16x16x32_bf16 a[8:11], v[48:51], v[40:43], 0
    v_mfma_f32_16x16x32_bf16 a[12:15], v[48:51], v[44:47], 0
    buffer_load_dwordx4 v[48:51], v2, s[12:15], s42 offen offset:0
    v_mfma_f32_16x16x32_bf16 a[16:19], v[52:55], v[32:35], 0
    v_mfma_f32_16x16x32_bf16 a[20:23], v[52:55], v[36:39], 0
    v_mfma_f32_16x16x32_bf16 a[24:27], v[52:55], v[40:43], 0
    v_mfma_f32_16x16x32_bf16 a[28:31], v[52:55], v[44:47], 0
    buffer_load_dwordx4 v[52:55], v2, s[12:15], s42 offen offset:1024
    v_mfma_f32_16x16x32_bf16 a[32:35], v[56:59], v[32:35], 0
    v_mfma_f32_16x16x32_bf16 a[36:39], v[56:59], v[36:39], 0
    v_mfma_f32_16x16x32_bf16 a[40:43], v[56:59], v[40:43], 0
    v_mfma_f32_16x16x32_bf16 a[44:47], v[56:59], v[44:47], 0
    buffer_load_dwordx4 v[56:59], v2, s[12:15], s42 offen offset:2048
    v_mfma_f32_16x16x32_bf16 a[48:51], v[60:63], v[32:35], 0
    v_mfma_f32_16x16x32_bf16 a[52:55], v[60:63], v[36:39], 0
    v_mfma_f32_16x16x32_bf16 a[56:59], v[60:63], v[40:43], 0
    v_mfma_f32_16x16x32_bf16 a[60:63], v[60:63], v[44:47], 0
    buffer_load_dwordx4 v[60:63], v2, s[12:15], s42 offen offset:3072
    v_mfma_f32_16x16x32_bf16 a[64:67], v[64:67], v[32:35], 0
    v_mfma_f32_16x16x32_bf16 a[68:71], v[64:67], v[36:39], 0
    v_mfma_f32_16x16x32_bf16 a[72:75], v[64:67], v[40:43], 0
    v_mfma_f32_16x16x32_bf16 a[76:79], v[64:67], v[44:47], 0
    buffer_load_dwordx4 v[64:67], v3, s[12:15], s42 offen
    buffer_load_dwordx4 v[32:35], v1, s[8:11], s40 offen offset:0
    buffer_load_dwordx4 v[36:39], v1, s[8:11], s40 offen offset:1024
    buffer_load_dwordx4 v[40:43], v1, s[8:11], s40 offen offset:2048
    buffer_load_dwordx4 v[44:47], v1, s[8:11], s40 offen offset:3072
    s_mul_i32 s52, s35, 1
    s_mul_i32 s54, s52, 65537
    s_lshr_b32 s54, s54, 16
    s_mul_i32 s54, s54, 1
    s_sub_u32 s52, s52, s54
    s_add_u32 s56, s55, 3145728
    s_add_u32 s57, s43, 983040
    s_mul_i32 s54, s52, 524288
    s_add_u32 s40, s56, s54
    s_mul_i32 s54, s52, 163840
    s_add_u32 s42, s57, s54
    s_waitcnt vmcnt(36)
    v_mfma_f32_16x16x32_bf16 a[0:3], v[84:87], v[68:71], a[0:3]
    v_mfma_f32_16x16x32_bf16 a[4:7], v[84:87], v[72:75], a[4:7]
    v_mfma_f32_16x16x32_bf16 a[8:11], v[84:87], v[76:79], a[8:11]
    v_mfma_f32_16x16x32_bf16 a[12:15], v[84:87], v[80:83], a[12:15]
    buffer_load_dwordx4 v[84:87], v2, s[12:15], s42 offen offset:0
    v_mfma_f32_16x16x32_bf16 a[16:19], v[88:91], v[68:71], a[16:19]
    v_mfma_f32_16x16x32_bf16 a[20:23], v[88:91], v[72:75], a[20:23]
    v_mfma_f32_16x16x32_bf16 a[24:27], v[88:91], v[76:79], a[24:27]
    v_mfma_f32_16x16x32_bf16 a[28:31], v[88:91], v[80:83], a[28:31]
    buffer_load_dwordx4 v[88:91], v2, s[12:15], s42 offen offset:1024
    v_mfma_f32_16x16x32_bf16 a[32:35], v[92:95], v[68:71], a[32:35]
    v_mfma_f32_16x16x32_bf16 a[36:39], v[92:95], v[72:75], a[36:39]
    v_mfma_f32_16x16x32_bf16 a[40:43], v[92:95], v[76:79], a[40:43]
    v_mfma_f32_16x16x32_bf16 a[44:47], v[92:95], v[80:83], a[44:47]
    buffer_load_dwordx4 v[92:95], v2, s[12:15], s42 offen offset:2048
    v_mfma_f32_16x16x32_bf16 a[48:51], v[96:99], v[68:71], a[48:51]
    v_mfma_f32_16x16x32_bf16 a[52:55], v[96:99], v[72:75], a[52:55]
    v_mfma_f32_16x16x32_bf16 a[56:59], v[96:99], v[76:79], a[56:59]
    v_mfma_f32_16x16x32_bf16 a[60:63], v[96:99], v[80:83], a[60:63]
    buffer_load_dwordx4 v[96:99], v2, s[12:15], s42 offen offset:3072
    v_mfma_f32_16x16x32_bf16 a[64:67], v[100:103], v[68:71], a[64:67]
    v_mfma_f32_16x16x32_bf16 a[68:71], v[100:103], v[72:75], a[68:71]
    v_mfma_f32_16x16x32_bf16 a[72:75], v[100:103], v[76:79], a[72:75]
    v_mfma_f32_16x16x32_bf16 a[76:79], v[100:103], v[80:83], a[76:79]
    buffer_load_dwordx4 v[100:103], v3, s[12:15], s42 offen
    buffer_load_dwordx4 v[68:71], v1, s[8:11], s40 offen offset:0
    buffer_load_dwordx4 v[72:75], v1, s[8:11], s40 offen offset:1024
    buffer_load_dwordx4 v[76:79], v1, s[8:11], s40 offen offset:2048
    buffer_load_dwordx4 v[80:83], v1, s[8:11], s40 offen offset:3072
    s_mul_i32 s52, s35, 1
    s_mul_i32 s54, s52, 65537
    s_lshr_b32 s54, s54, 16
    s_mul_i32 s54, s54, 1
    s_sub_u32 s52, s52, s54
    s_add_u32 s56, s55, 3670016
    s_add_u32 s57, s43, 1146880
    s_mul_i32 s54, s52, 524288
    s_add_u32 s40, s56, s54
    s_mul_i32 s54, s52, 163840
    s_add_u32 s42, s57, s54
    s_waitcnt vmcnt(36)
    v_mfma_f32_16x16x32_bf16 a[0:3], v[120:123], v[104:107], a[0:3]
    v_mfma_f32_16x16x32_bf16 a[4:7], v[120:123], v[108:111], a[4:7]
    v_mfma_f32_16x16x32_bf16 a[8:11], v[120:123], v[112:115], a[8:11]
    v_mfma_f32_16x16x32_bf16 a[12:15], v[120:123], v[116:119], a[12:15]
    buffer_load_dwordx4 v[120:123], v2, s[12:15], s42 offen offset:0
    v_mfma_f32_16x16x32_bf16 a[16:19], v[124:127], v[104:107], a[16:19]
    v_mfma_f32_16x16x32_bf16 a[20:23], v[124:127], v[108:111], a[20:23]
    v_mfma_f32_16x16x32_bf16 a[24:27], v[124:127], v[112:115], a[24:27]
    v_mfma_f32_16x16x32_bf16 a[28:31], v[124:127], v[116:119], a[28:31]
    buffer_load_dwordx4 v[124:127], v2, s[12:15], s42 offen offset:1024
    v_mfma_f32_16x16x32_bf16 a[32:35], v[128:131], v[104:107], a[32:35]
    v_mfma_f32_16x16x32_bf16 a[36:39], v[128:131], v[108:111], a[36:39]
    v_mfma_f32_16x16x32_bf16 a[40:43], v[128:131], v[112:115], a[40:43]
    v_mfma_f32_16x16x32_bf16 a[44:47], v[128:131], v[116:119], a[44:47]
    buffer_load_dwordx4 v[128:131], v2, s[12:15], s42 offen offset:2048
    v_mfma_f32_16x16x32_bf16 a[48:51], v[132:135], v[104:107], a[48:51]
    v_mfma_f32_16x16x32_bf16 a[52:55], v[132:135], v[108:111], a[52:55]
    v_mfma_f32_16x16x32_bf16 a[56:59], v[132:135], v[112:115], a[56:59]
    v_mfma_f32_16x16x32_bf16 a[60:63], v[132:135], v[116:119], a[60:63]
    buffer_load_dwordx4 v[132:135], v2, s[12:15], s42 offen offset:3072
    v_mfma_f32_16x16x32_bf16 a[64:67], v[136:139], v[104:107], a[64:67]
    v_mfma_f32_16x16x32_bf16 a[68:71], v[136:139], v[108:111], a[68:71]
    v_mfma_f32_16x16x32_bf16 a[72:75], v[136:139], v[112:115], a[72:75]
    v_mfma_f32_16x16x32_bf16 a[76:79], v[136:139], v[116:119], a[76:79]
    buffer_load_dwordx4 v[136:139], v3, s[12:15], s42 offen
    buffer_load_dwordx4 v[104:107], v1, s[8:11], s40 offen offset:0
    buffer_load_dwordx4 v[108:111], v1, s[8:11], s40 offen offset:1024
    buffer_load_dwordx4 v[112:115], v1, s[8:11], s40 offen offset:2048
    buffer_load_dwordx4 v[116:119], v1, s[8:11], s40 offen offset:3072
    s_mul_i32 s52, s35, 1
    s_mul_i32 s54, s52, 65537
    s_lshr_b32 s54, s54, 16
    s_mul_i32 s54, s54, 1
    s_sub_u32 s52, s52, s54
    s_add_u32 s56, s55, 4194304
    s_add_u32 s57, s43, 1310720
    s_mul_i32 s54, s52, 524288
    s_add_u32 s40, s56, s54
    s_mul_i32 s54, s52, 163840
    s_add_u32 s42, s57, s54
    s_waitcnt vmcnt(36)
    v_mfma_f32_16x16x32_bf16 a[0:3], v[156:159], v[140:143], a[0:3]
    v_mfma_f32_16x16x32_bf16 a[4:7], v[156:159], v[144:147], a[4:7]
    v_mfma_f32_16x16x32_bf16 a[8:11], v[156:159], v[148:151], a[8:11]
    v_mfma_f32_16x16x32_bf16 a[12:15], v[156:159], v[152:155], a[12:15]
    buffer_load_dwordx4 v[156:159], v2, s[12:15], s42 offen offset:0
    v_mfma_f32_16x16x32_bf16 a[16:19], v[160:163], v[140:143], a[16:19]
    v_mfma_f32_16x16x32_bf16 a[20:23], v[160:163], v[144:147], a[20:23]
    v_mfma_f32_16x16x32_bf16 a[24:27], v[160:163], v[148:151], a[24:27]
    v_mfma_f32_16x16x32_bf16 a[28:31], v[160:163], v[152:155], a[28:31]
    buffer_load_dwordx4 v[160:163], v2, s[12:15], s42 offen offset:1024
    v_mfma_f32_16x16x32_bf16 a[32:35], v[164:167], v[140:143], a[32:35]
    v_mfma_f32_16x16x32_bf16 a[36:39], v[164:167], v[144:147], a[36:39]
    v_mfma_f32_16x16x32_bf16 a[40:43], v[164:167], v[148:151], a[40:43]
    v_mfma_f32_16x16x32_bf16 a[44:47], v[164:167], v[152:155], a[44:47]
    buffer_load_dwordx4 v[164:167], v2, s[12:15], s42 offen offset:2048
    v_mfma_f32_16x16x32_bf16 a[48:51], v[168:171], v[140:143], a[48:51]
    v_mfma_f32_16x16x32_bf16 a[52:55], v[168:171], v[144:147], a[52:55]
    v_mfma_f32_16x16x32_bf16 a[56:59], v[168:171], v[148:151], a[56:59]
    v_mfma_f32_16x16x32_bf16 a[60:63], v[168:171], v[152:155], a[60:63]
    buffer_load_dwordx4 v[168:171], v2, s[12:15], s42 offen offset:3072
    v_mfma_f32_16x16x32_bf16 a[64:67], v[172:175], v[140:143], a[64:67]
    v_mfma_f32_16x16x32_bf16 a[68:71], v[172:175], v[144:147], a[68:71]
    v_mfma_f32_16x16x32_bf16 a[72:75], v[172:175], v[148:151], a[72:75]
    v_mfma_f32_16x16x32_bf16 a[76:79], v[172:175], v[152:155], a[76:79]
    buffer_load_dwordx4 v[172:175], v3, s[12:15], s42 offen
    buffer_load_dwordx4 v[140:143], v1, s[8:11], s40 offen offset:0
    buffer_load_dwordx4 v[144:147], v1, s[8:11], s40 offen offset:1024
    buffer_load_dwordx4 v[148:151], v1, s[8:11], s40 offen offset:2048
    buffer_load_dwordx4 v[152:155], v1, s[8:11], s40 offen offset:3072
    s_mul_i32 s52, s35, 1
    s_mul_i32 s54, s52, 65537
    s_lshr_b32 s54, s54, 16
    s_mul_i32 s54, s54, 1
    s_sub_u32 s52, s52, s54
    s_add_u32 s56, s55, 4718592
    s_add_u32 s57, s43, 1474560
    s_mul_i32 s54, s52, 524288
    s_add_u32 s40, s56, s54
    s_mul_i32 s54, s52, 163840
    s_add_u32 s42, s57, s54
    s_waitcnt vmcnt(36)
    v_mfma_f32_16x16x32_bf16 a[0:3], v[192:195], v[176:179], a[0:3]
    v_mfma_f32_16x16x32_bf16 a[4:7], v[192:195], v[180:183], a[4:7]
    v_mfma_f32_16x16x32_bf16 a[8:11], v[192:195], v[184:187], a[8:11]
    v_mfma_f32_16x16x32_bf16 a[12:15], v[192:195], v[188:191], a[12:15]
    buffer_load_dwordx4 v[192:195], v2, s[12:15], s42 offen offset:0
    v_mfma_f32_16x16x32_bf16 a[16:19], v[196:199], v[176:179], a[16:19]
    v_mfma_f32_16x16x32_bf16 a[20:23], v[196:199], v[180:183], a[20:23]
    v_mfma_f32_16x16x32_bf16 a[24:27], v[196:199], v[184:187], a[24:27]
    v_mfma_f32_16x16x32_bf16 a[28:31], v[196:199], v[188:191], a[28:31]
    buffer_load_dwordx4 v[196:199], v2, s[12:15], s42 offen offset:1024
    v_mfma_f32_16x16x32_bf16 a[32:35], v[200:203], v[176:179], a[32:35]
    v_mfma_f32_16x16x32_bf16 a[36:39], v[200:203], v[180:183], a[36:39]
    v_mfma_f32_16x16x32_bf16 a[40:43], v[200:203], v[184:187], a[40:43]
    v_mfma_f32_16x16x32_bf16 a[44:47], v[200:203], v[188:191], a[44:47]
    buffer_load_dwordx4 v[200:203], v2, s[12:15], s42 offen offset:2048
    v_mfma_f32_16x16x32_bf16 a[48:51], v[204:207], v[176:179], a[48:51]
    v_mfma_f32_16x16x32_bf16 a[52:55], v[204:207], v[180:183], a[52:55]
    v_mfma_f32_16x16x32_bf16 a[56:59], v[204:207], v[184:187], a[56:59]
    v_mfma_f32_16x16x32_bf16 a[60:63], v[204:207], v[188:191], a[60:63]
    buffer_load_dwordx4 v[204:207], v2, s[12:15], s42 offen offset:3072
    v_mfma_f32_16x16x32_bf16 a[64:67], v[208:211], v[176:179], a[64:67]
    v_mfma_f32_16x16x32_bf16 a[68:71], v[208:211], v[180:183], a[68:71]
    v_mfma_f32_16x16x32_bf16 a[72:75], v[208:211], v[184:187], a[72:75]
    v_mfma_f32_16x16x32_bf16 a[76:79], v[208:211], v[188:191], a[76:79]
    buffer_load_dwordx4 v[208:211], v3, s[12:15], s42 offen
    buffer_load_dwordx4 v[176:179], v1, s[8:11], s40 offen offset:0
    buffer_load_dwordx4 v[180:183], v1, s[8:11], s40 offen offset:1024
    buffer_load_dwordx4 v[184:187], v1, s[8:11], s40 offen offset:2048
    buffer_load_dwordx4 v[188:191], v1, s[8:11], s40 offen offset:3072
    s_mul_i32 s52, s35, 1
    s_mul_i32 s54, s52, 65537
    s_lshr_b32 s54, s54, 16
    s_mul_i32 s54, s54, 1
    s_sub_u32 s52, s52, s54
    s_add_u32 s56, s55, 5242880
    s_add_u32 s57, s43, 1638400
    s_mul_i32 s54, s52, 524288
    s_add_u32 s40, s56, s54
    s_mul_i32 s54, s52, 163840
    s_add_u32 s42, s57, s54
    s_waitcnt vmcnt(36)
    v_mfma_f32_16x16x32_bf16 a[0:3], v[48:51], v[32:35], a[0:3]
    v_mfma_f32_16x16x32_bf16 a[4:7], v[48:51], v[36:39], a[4:7]
    v_mfma_f32_16x16x32_bf16 a[8:11], v[48:51], v[40:43], a[8:11]
    v_mfma_f32_16x16x32_bf16 a[12:15], v[48:51], v[44:47], a[12:15]
    buffer_load_dwordx4 v[48:51], v2, s[12:15], s42 offen offset:0
    v_mfma_f32_16x16x32_bf16 a[16:19], v[52:55], v[32:35], a[16:19]
    v_mfma_f32_16x16x32_bf16 a[20:23], v[52:55], v[36:39], a[20:23]
    v_mfma_f32_16x16x32_bf16 a[24:27], v[52:55], v[40:43], a[24:27]
    v_mfma_f32_16x16x32_bf16 a[28:31], v[52:55], v[44:47], a[28:31]
    buffer_load_dwordx4 v[52:55], v2, s[12:15], s42 offen offset:1024
    v_mfma_f32_16x16x32_bf16 a[32:35], v[56:59], v[32:35], a[32:35]
    v_mfma_f32_16x16x32_bf16 a[36:39], v[56:59], v[36:39], a[36:39]
    v_mfma_f32_16x16x32_bf16 a[40:43], v[56:59], v[40:43], a[40:43]
    v_mfma_f32_16x16x32_bf16 a[44:47], v[56:59], v[44:47], a[44:47]
    buffer_load_dwordx4 v[56:59], v2, s[12:15], s42 offen offset:2048
    v_mfma_f32_16x16x32_bf16 a[48:51], v[60:63], v[32:35], a[48:51]
    v_mfma_f32_16x16x32_bf16 a[52:55], v[60:63], v[36:39], a[52:55]
    v_mfma_f32_16x16x32_bf16 a[56:59], v[60:63], v[40:43], a[56:59]
    v_mfma_f32_16x16x32_bf16 a[60:63], v[60:63], v[44:47], a[60:63]
    buffer_load_dwordx4 v[60:63], v2, s[12:15], s42 offen offset:3072
    v_mfma_f32_16x16x32_bf16 a[64:67], v[64:67], v[32:35], a[64:67]
    v_mfma_f32_16x16x32_bf16 a[68:71], v[64:67], v[36:39], a[68:71]
    v_mfma_f32_16x16x32_bf16 a[72:75], v[64:67], v[40:43], a[72:75]
    v_mfma_f32_16x16x32_bf16 a[76:79], v[64:67], v[44:47], a[76:79]
    buffer_load_dwordx4 v[64:67], v3, s[12:15], s42 offen
    buffer_load_dwordx4 v[32:35], v1, s[8:11], s40 offen offset:0
    buffer_load_dwordx4 v[36:39], v1, s[8:11], s40 offen offset:1024
    buffer_load_dwordx4 v[40:43], v1, s[8:11], s40 offen offset:2048
    buffer_load_dwordx4 v[44:47], v1, s[8:11], s40 offen offset:3072
    s_mul_i32 s52, s35, 1
    s_mul_i32 s54, s52, 65537
    s_lshr_b32 s54, s54, 16
    s_mul_i32 s54, s54, 1
    s_sub_u32 s52, s52, s54
    s_add_u32 s56, s55, 5767168
    s_add_u32 s57, s43, 1802240
    s_mul_i32 s54, s52, 524288
    s_add_u32 s40, s56, s54
    s_mul_i32 s54, s52, 163840
    s_add_u32 s42, s57, s54
    s_waitcnt vmcnt(36)
    v_mfma_f32_16x16x32_bf16 a[0:3], v[84:87], v[68:71], a[0:3]
    v_mfma_f32_16x16x32_bf16 a[4:7], v[84:87], v[72:75], a[4:7]
    v_mfma_f32_16x16x32_bf16 a[8:11], v[84:87], v[76:79], a[8:11]
    v_mfma_f32_16x16x32_bf16 a[12:15], v[84:87], v[80:83], a[12:15]
    buffer_load_dwordx4 v[84:87], v2, s[12:15], s42 offen offset:0
    v_mfma_f32_16x16x32_bf16 a[16:19], v[88:91], v[68:71], a[16:19]
    v_mfma_f32_16x16x32_bf16 a[20:23], v[88:91], v[72:75], a[20:23]
    v_mfma_f32_16x16x32_bf16 a[24:27], v[88:91], v[76:79], a[24:27]
    v_mfma_f32_16x16x32_bf16 a[28:31], v[88:91], v[80:83], a[28:31]
    buffer_load_dwordx4 v[88:91], v2, s[12:15], s42 offen offset:1024
    v_mfma_f32_16x16x32_bf16 a[32:35], v[92:95], v[68:71], a[32:35]
    v_mfma_f32_16x16x32_bf16 a[36:39], v[92:95], v[72:75], a[36:39]
    v_mfma_f32_16x16x32_bf16 a[40:43], v[92:95], v[76:79], a[40:43]
    v_mfma_f32_16x16x32_bf16 a[44:47], v[92:95], v[80:83], a[44:47]
    buffer_load_dwordx4 v[92:95], v2, s[12:15], s42 offen offset:2048
    v_mfma_f32_16x16x32_bf16 a[48:51], v[96:99], v[68:71], a[48:51]
    v_mfma_f32_16x16x32_bf16 a[52:55], v[96:99], v[72:75], a[52:55]
    v_mfma_f32_16x16x32_bf16 a[56:59], v[96:99], v[76:79], a[56:59]
    v_mfma_f32_16x16x32_bf16 a[60:63], v[96:99], v[80:83], a[60:63]
    buffer_load_dwordx4 v[96:99], v2, s[12:15], s42 offen offset:3072
    v_mfma_f32_16x16x32_bf16 a[64:67], v[100:103], v[68:71], a[64:67]
    v_mfma_f32_16x16x32_bf16 a[68:71], v[100:103], v[72:75], a[68:71]
    v_mfma_f32_16x16x32_bf16 a[72:75], v[100:103], v[76:79], a[72:75]
    v_mfma_f32_16x16x32_bf16 a[76:79], v[100:103], v[80:83], a[76:79]
    buffer_load_dwordx4 v[100:103], v3, s[12:15], s42 offen
    buffer_load_dwordx4 v[68:71], v1, s[8:11], s40 offen offset:0
    buffer_load_dwordx4 v[72:75], v1, s[8:11], s40 offen offset:1024
    buffer_load_dwordx4 v[76:79], v1, s[8:11], s40 offen offset:2048
    buffer_load_dwordx4 v[80:83], v1, s[8:11], s40 offen offset:3072
    s_mul_i32 s52, s35, 1
    s_mul_i32 s54, s52, 65537
    s_lshr_b32 s54, s54, 16
    s_mul_i32 s54, s54, 1
    s_sub_u32 s52, s52, s54
    s_add_u32 s56, s55, 6291456
    s_add_u32 s57, s43, 1966080
    s_mul_i32 s54, s52, 524288
    s_add_u32 s40, s56, s54
    s_mul_i32 s54, s52, 163840
    s_add_u32 s42, s57, s54
    s_waitcnt vmcnt(36)
    v_mfma_f32_16x16x32_bf16 a[0:3], v[120:123], v[104:107], a[0:3]
    v_mfma_f32_16x16x32_bf16 a[4:7], v[120:123], v[108:111], a[4:7]
    v_mfma_f32_16x16x32_bf16 a[8:11], v[120:123], v[112:115], a[8:11]
    v_mfma_f32_16x16x32_bf16 a[12:15], v[120:123], v[116:119], a[12:15]
    buffer_load_dwordx4 v[120:123], v2, s[12:15], s42 offen offset:0
    v_mfma_f32_16x16x32_bf16 a[16:19], v[124:127], v[104:107], a[16:19]
    v_mfma_f32_16x16x32_bf16 a[20:23], v[124:127], v[108:111], a[20:23]
    v_mfma_f32_16x16x32_bf16 a[24:27], v[124:127], v[112:115], a[24:27]
    v_mfma_f32_16x16x32_bf16 a[28:31], v[124:127], v[116:119], a[28:31]
    buffer_load_dwordx4 v[124:127], v2, s[12:15], s42 offen offset:1024
    v_mfma_f32_16x16x32_bf16 a[32:35], v[128:131], v[104:107], a[32:35]
    v_mfma_f32_16x16x32_bf16 a[36:39], v[128:131], v[108:111], a[36:39]
    v_mfma_f32_16x16x32_bf16 a[40:43], v[128:131], v[112:115], a[40:43]
    v_mfma_f32_16x16x32_bf16 a[44:47], v[128:131], v[116:119], a[44:47]
    buffer_load_dwordx4 v[128:131], v2, s[12:15], s42 offen offset:2048
    v_mfma_f32_16x16x32_bf16 a[48:51], v[132:135], v[104:107], a[48:51]
    v_mfma_f32_16x16x32_bf16 a[52:55], v[132:135], v[108:111], a[52:55]
    v_mfma_f32_16x16x32_bf16 a[56:59], v[132:135], v[112:115], a[56:59]
    v_mfma_f32_16x16x32_bf16 a[60:63], v[132:135], v[116:119], a[60:63]
    buffer_load_dwordx4 v[132:135], v2, s[12:15], s42 offen offset:3072
    v_mfma_f32_16x16x32_bf16 a[64:67], v[136:139], v[104:107], a[64:67]
    v_mfma_f32_16x16x32_bf16 a[68:71], v[136:139], v[108:111], a[68:71]
    v_mfma_f32_16x16x32_bf16 a[72:75], v[136:139], v[112:115], a[72:75]
    v_mfma_f32_16x16x32_bf16 a[76:79], v[136:139], v[116:119], a[76:79]
    buffer_load_dwordx4 v[136:139], v3, s[12:15], s42 offen
    buffer_load_dwordx4 v[104:107], v1, s[8:11], s40 offen offset:0
    buffer_load_dwordx4 v[108:111], v1, s[8:11], s40 offen offset:1024
    buffer_load_dwordx4 v[112:115], v1, s[8:11], s40 offen offset:2048
    buffer_load_dwordx4 v[116:119], v1, s[8:11], s40 offen offset:3072
    s_mul_i32 s52, s35, 1
    s_mul_i32 s54, s52, 65537
    s_lshr_b32 s54, s54, 16
    s_mul_i32 s54, s54, 1
    s_sub_u32 s52, s52, s54
    s_add_u32 s56, s55, 6815744
    s_add_u32 s57, s43, 2129920
    s_mul_i32 s54, s52, 524288
    s_add_u32 s40, s56, s54
    s_mul_i32 s54, s52, 163840
    s_add_u32 s42, s57, s54
    s_waitcnt vmcnt(36)
    v_mfma_f32_16x16x32_bf16 a[0:3], v[156:159], v[140:143], a[0:3]
    v_mfma_f32_16x16x32_bf16 a[4:7], v[156:159], v[144:147], a[4:7]
    v_mfma_f32_16x16x32_bf16 a[8:11], v[156:159], v[148:151], a[8:11]
    v_mfma_f32_16x16x32_bf16 a[12:15], v[156:159], v[152:155], a[12:15]
    buffer_load_dwordx4 v[156:159], v2, s[12:15], s42 offen offset:0
    v_mfma_f32_16x16x32_bf16 a[16:19], v[160:163], v[140:143], a[16:19]
    v_mfma_f32_16x16x32_bf16 a[20:23], v[160:163], v[144:147], a[20:23]
    v_mfma_f32_16x16x32_bf16 a[24:27], v[160:163], v[148:151], a[24:27]
    v_mfma_f32_16x16x32_bf16 a[28:31], v[160:163], v[152:155], a[28:31]
    buffer_load_dwordx4 v[160:163], v2, s[12:15], s42 offen offset:1024
    v_mfma_f32_16x16x32_bf16 a[32:35], v[164:167], v[140:143], a[32:35]
    v_mfma_f32_16x16x32_bf16 a[36:39], v[164:167], v[144:147], a[36:39]
    v_mfma_f32_16x16x32_bf16 a[40:43], v[164:167], v[148:151], a[40:43]
    v_mfma_f32_16x16x32_bf16 a[44:47], v[164:167], v[152:155], a[44:47]
    buffer_load_dwordx4 v[164:167], v2, s[12:15], s42 offen offset:2048
    v_mfma_f32_16x16x32_bf16 a[48:51], v[168:171], v[140:143], a[48:51]
    v_mfma_f32_16x16x32_bf16 a[52:55], v[168:171], v[144:147], a[52:55]
    v_mfma_f32_16x16x32_bf16 a[56:59], v[168:171], v[148:151], a[56:59]
    v_mfma_f32_16x16x32_bf16 a[60:63], v[168:171], v[152:155], a[60:63]
    buffer_load_dwordx4 v[168:171], v2, s[12:15], s42 offen offset:3072
    v_mfma_f32_16x16x32_bf16 a[64:67], v[172:175], v[140:143], a[64:67]
    v_mfma_f32_16x16x32_bf16 a[68:71], v[172:175], v[144:147], a[68:71]
    v_mfma_f32_16x16x32_bf16 a[72:75], v[172:175], v[148:151], a[72:75]
    v_mfma_f32_16x16x32_bf16 a[76:79], v[172:175], v[152:155], a[76:79]
    buffer_load_dwordx4 v[172:175], v3, s[12:15], s42 offen
    buffer_load_dwordx4 v[140:143], v1, s[8:11], s40 offen offset:0
    buffer_load_dwordx4 v[144:147], v1, s[8:11], s40 offen offset:1024
    buffer_load_dwordx4 v[148:151], v1, s[8:11], s40 offen offset:2048
    buffer_load_dwordx4 v[152:155], v1, s[8:11], s40 offen offset:3072
    s_mul_i32 s52, s35, 1
    s_mul_i32 s54, s52, 65537
    s_lshr_b32 s54, s54, 16
    s_mul_i32 s54, s54, 1
    s_sub_u32 s52, s52, s54
    s_add_u32 s56, s55, 7340032
    s_add_u32 s57, s43, 2293760
    s_mul_i32 s54, s52, 524288
    s_add_u32 s40, s56, s54
    s_mul_i32 s54, s52, 163840
    s_add_u32 s42, s57, s54
    s_waitcnt vmcnt(36)
    v_mfma_f32_16x16x32_bf16 a[0:3], v[192:195], v[176:179], a[0:3]
    v_mfma_f32_16x16x32_bf16 a[4:7], v[192:195], v[180:183], a[4:7]
    v_mfma_f32_16x16x32_bf16 a[8:11], v[192:195], v[184:187], a[8:11]
    v_mfma_f32_16x16x32_bf16 a[12:15], v[192:195], v[188:191], a[12:15]
    buffer_load_dwordx4 v[192:195], v2, s[12:15], s42 offen offset:0
    v_mfma_f32_16x16x32_bf16 a[16:19], v[196:199], v[176:179], a[16:19]
    v_mfma_f32_16x16x32_bf16 a[20:23], v[196:199], v[180:183], a[20:23]
    v_mfma_f32_16x16x32_bf16 a[24:27], v[196:199], v[184:187], a[24:27]
    v_mfma_f32_16x16x32_bf16 a[28:31], v[196:199], v[188:191], a[28:31]
    buffer_load_dwordx4 v[196:199], v2, s[12:15], s42 offen offset:1024
    v_mfma_f32_16x16x32_bf16 a[32:35], v[200:203], v[176:179], a[32:35]
    v_mfma_f32_16x16x32_bf16 a[36:39], v[200:203], v[180:183], a[36:39]
    v_mfma_f32_16x16x32_bf16 a[40:43], v[200:203], v[184:187], a[40:43]
    v_mfma_f32_16x16x32_bf16 a[44:47], v[200:203], v[188:191], a[44:47]
    buffer_load_dwordx4 v[200:203], v2, s[12:15], s42 offen offset:2048
    v_mfma_f32_16x16x32_bf16 a[48:51], v[204:207], v[176:179], a[48:51]
    v_mfma_f32_16x16x32_bf16 a[52:55], v[204:207], v[180:183], a[52:55]
    v_mfma_f32_16x16x32_bf16 a[56:59], v[204:207], v[184:187], a[56:59]
    v_mfma_f32_16x16x32_bf16 a[60:63], v[204:207], v[188:191], a[60:63]
    buffer_load_dwordx4 v[204:207], v2, s[12:15], s42 offen offset:3072
    v_mfma_f32_16x16x32_bf16 a[64:67], v[208:211], v[176:179], a[64:67]
    v_mfma_f32_16x16x32_bf16 a[68:71], v[208:211], v[180:183], a[68:71]
    v_mfma_f32_16x16x32_bf16 a[72:75], v[208:211], v[184:187], a[72:75]
    v_mfma_f32_16x16x32_bf16 a[76:79], v[208:211], v[188:191], a[76:79]
    buffer_load_dwordx4 v[208:211], v3, s[12:15], s42 offen
    buffer_load_dwordx4 v[176:179], v1, s[8:11], s40 offen offset:0
    buffer_load_dwordx4 v[180:183], v1, s[8:11], s40 offen offset:1024
    buffer_load_dwordx4 v[184:187], v1, s[8:11], s40 offen offset:2048
    buffer_load_dwordx4 v[188:191], v1, s[8:11], s40 offen offset:3072
    s_mul_i32 s52, s35, 1
    s_mul_i32 s54, s52, 65537
    s_lshr_b32 s54, s54, 16
    s_mul_i32 s54, s54, 1
    s_sub_u32 s52, s52, s54
    s_add_u32 s56, s55, 7864320
    s_add_u32 s57, s43, 2457600
    s_mul_i32 s54, s52, 524288
    s_add_u32 s40, s56, s54
    s_mul_i32 s54, s52, 163840
    s_add_u32 s42, s57, s54
    s_waitcnt vmcnt(36)
    v_mfma_f32_16x16x32_bf16 a[0:3], v[48:51], v[32:35], a[0:3]
    v_mfma_f32_16x16x32_bf16 a[4:7], v[48:51], v[36:39], a[4:7]
    v_mfma_f32_16x16x32_bf16 a[8:11], v[48:51], v[40:43], a[8:11]
    v_mfma_f32_16x16x32_bf16 a[12:15], v[48:51], v[44:47], a[12:15]
    buffer_load_dwordx4 v[48:51], v2, s[12:15], s42 offen offset:0
    v_mfma_f32_16x16x32_bf16 a[16:19], v[52:55], v[32:35], a[16:19]
    v_mfma_f32_16x16x32_bf16 a[20:23], v[52:55], v[36:39], a[20:23]
    v_mfma_f32_16x16x32_bf16 a[24:27], v[52:55], v[40:43], a[24:27]
    v_mfma_f32_16x16x32_bf16 a[28:31], v[52:55], v[44:47], a[28:31]
    buffer_load_dwordx4 v[52:55], v2, s[12:15], s42 offen offset:1024
    v_mfma_f32_16x16x32_bf16 a[32:35], v[56:59], v[32:35], a[32:35]
    v_mfma_f32_16x16x32_bf16 a[36:39], v[56:59], v[36:39], a[36:39]
    v_mfma_f32_16x16x32_bf16 a[40:43], v[56:59], v[40:43], a[40:43]
    v_mfma_f32_16x16x32_bf16 a[44:47], v[56:59], v[44:47], a[44:47]
    buffer_load_dwordx4 v[56:59], v2, s[12:15], s42 offen offset:2048
    v_mfma_f32_16x16x32_bf16 a[48:51], v[60:63], v[32:35], a[48:51]
    v_mfma_f32_16x16x32_bf16 a[52:55], v[60:63], v[36:39], a[52:55]
    v_mfma_f32_16x16x32_bf16 a[56:59], v[60:63], v[40:43], a[56:59]
    v_mfma_f32_16x16x32_bf16 a[60:63], v[60:63], v[44:47], a[60:63]
    buffer_load_dwordx4 v[60:63], v2, s[12:15], s42 offen offset:3072
    v_mfma_f32_16x16x32_bf16 a[64:67], v[64:67], v[32:35], a[64:67]
    v_mfma_f32_16x16x32_bf16 a[68:71], v[64:67], v[36:39], a[68:71]
    v_mfma_f32_16x16x32_bf16 a[72:75], v[64:67], v[40:43], a[72:75]
    v_mfma_f32_16x16x32_bf16 a[76:79], v[64:67], v[44:47], a[76:79]
    buffer_load_dwordx4 v[64:67], v3, s[12:15], s42 offen
    buffer_load_dwordx4 v[32:35], v1, s[8:11], s40 offen offset:0
    buffer_load_dwordx4 v[36:39], v1, s[8:11], s40 offen offset:1024
    buffer_load_dwordx4 v[40:43], v1, s[8:11], s40 offen offset:2048
    buffer_load_dwordx4 v[44:47], v1, s[8:11], s40 offen offset:3072
    s_mul_i32 s52, s35, 1
    s_mul_i32 s54, s52, 65537
    s_lshr_b32 s54, s54, 16
    s_mul_i32 s54, s54, 1
    s_sub_u32 s52, s52, s54
    s_add_u32 s56, s55, 8388608
    s_add_u32 s57, s43, 2621440
    s_mul_i32 s54, s52, 524288
    s_add_u32 s40, s56, s54
    s_mul_i32 s54, s52, 163840
    s_add_u32 s42, s57, s54
    s_waitcnt vmcnt(36)
    v_mfma_f32_16x16x32_bf16 a[0:3], v[84:87], v[68:71], a[0:3]
    v_mfma_f32_16x16x32_bf16 a[4:7], v[84:87], v[72:75], a[4:7]
    v_mfma_f32_16x16x32_bf16 a[8:11], v[84:87], v[76:79], a[8:11]
    v_mfma_f32_16x16x32_bf16 a[12:15], v[84:87], v[80:83], a[12:15]
    buffer_load_dwordx4 v[84:87], v2, s[12:15], s42 offen offset:0
    v_mfma_f32_16x16x32_bf16 a[16:19], v[88:91], v[68:71], a[16:19]
    v_mfma_f32_16x16x32_bf16 a[20:23], v[88:91], v[72:75], a[20:23]
    v_mfma_f32_16x16x32_bf16 a[24:27], v[88:91], v[76:79], a[24:27]
    v_mfma_f32_16x16x32_bf16 a[28:31], v[88:91], v[80:83], a[28:31]
    buffer_load_dwordx4 v[88:91], v2, s[12:15], s42 offen offset:1024
    v_mfma_f32_16x16x32_bf16 a[32:35], v[92:95], v[68:71], a[32:35]
    v_mfma_f32_16x16x32_bf16 a[36:39], v[92:95], v[72:75], a[36:39]
    v_mfma_f32_16x16x32_bf16 a[40:43], v[92:95], v[76:79], a[40:43]
    v_mfma_f32_16x16x32_bf16 a[44:47], v[92:95], v[80:83], a[44:47]
    buffer_load_dwordx4 v[92:95], v2, s[12:15], s42 offen offset:2048
    v_mfma_f32_16x16x32_bf16 a[48:51], v[96:99], v[68:71], a[48:51]
    v_mfma_f32_16x16x32_bf16 a[52:55], v[96:99], v[72:75], a[52:55]
    v_mfma_f32_16x16x32_bf16 a[56:59], v[96:99], v[76:79], a[56:59]
    v_mfma_f32_16x16x32_bf16 a[60:63], v[96:99], v[80:83], a[60:63]
    buffer_load_dwordx4 v[96:99], v2, s[12:15], s42 offen offset:3072
    v_mfma_f32_16x16x32_bf16 a[64:67], v[100:103], v[68:71], a[64:67]
    v_mfma_f32_16x16x32_bf16 a[68:71], v[100:103], v[72:75], a[68:71]
    v_mfma_f32_16x16x32_bf16 a[72:75], v[100:103], v[76:79], a[72:75]
    v_mfma_f32_16x16x32_bf16 a[76:79], v[100:103], v[80:83], a[76:79]
    buffer_load_dwordx4 v[100:103], v3, s[12:15], s42 offen
    buffer_load_dwordx4 v[68:71], v1, s[8:11], s40 offen offset:0
    buffer_load_dwordx4 v[72:75], v1, s[8:11], s40 offen offset:1024
    buffer_load_dwordx4 v[76:79], v1, s[8:11], s40 offen offset:2048
    buffer_load_dwordx4 v[80:83], v1, s[8:11], s40 offen offset:3072
    s_mul_i32 s52, s35, 1
    s_mul_i32 s54, s52, 65537
    s_lshr_b32 s54, s54, 16
    s_mul_i32 s54, s54, 1
    s_sub_u32 s52, s52, s54
    s_add_u32 s56, s55, 8912896
    s_add_u32 s57, s43, 2785280
    s_mul_i32 s54, s52, 524288
    s_add_u32 s40, s56, s54
    s_mul_i32 s54, s52, 163840
    s_add_u32 s42, s57, s54
    s_waitcnt vmcnt(36)
    v_mfma_f32_16x16x32_bf16 a[0:3], v[120:123], v[104:107], a[0:3]
    v_mfma_f32_16x16x32_bf16 a[4:7], v[120:123], v[108:111], a[4:7]
    v_mfma_f32_16x16x32_bf16 a[8:11], v[120:123], v[112:115], a[8:11]
    v_mfma_f32_16x16x32_bf16 a[12:15], v[120:123], v[116:119], a[12:15]
    buffer_load_dwordx4 v[120:123], v2, s[12:15], s42 offen offset:0
    v_mfma_f32_16x16x32_bf16 a[16:19], v[124:127], v[104:107], a[16:19]
    v_mfma_f32_16x16x32_bf16 a[20:23], v[124:127], v[108:111], a[20:23]
    v_mfma_f32_16x16x32_bf16 a[24:27], v[124:127], v[112:115], a[24:27]
    v_mfma_f32_16x16x32_bf16 a[28:31], v[124:127], v[116:119], a[28:31]
    buffer_load_dwordx4 v[124:127], v2, s[12:15], s42 offen offset:1024
    v_mfma_f32_16x16x32_bf16 a[32:35], v[128:131], v[104:107], a[32:35]
    v_mfma_f32_16x16x32_bf16 a[36:39], v[128:131], v[108:111], a[36:39]
    v_mfma_f32_16x16x32_bf16 a[40:43], v[128:131], v[112:115], a[40:43]
    v_mfma_f32_16x16x32_bf16 a[44:47], v[128:131], v[116:119], a[44:47]
    buffer_load_dwordx4 v[128:131], v2, s[12:15], s42 offen offset:2048
    v_mfma_f32_16x16x32_bf16 a[48:51], v[132:135], v[104:107], a[48:51]
    v_mfma_f32_16x16x32_bf16 a[52:55], v[132:135], v[108:111], a[52:55]
    v_mfma_f32_16x16x32_bf16 a[56:59], v[132:135], v[112:115], a[56:59]
    v_mfma_f32_16x16x32_bf16 a[60:63], v[132:135], v[116:119], a[60:63]
    buffer_load_dwordx4 v[132:135], v2, s[12:15], s42 offen offset:3072
    v_mfma_f32_16x16x32_bf16 a[64:67], v[136:139], v[104:107], a[64:67]
    v_mfma_f32_16x16x32_bf16 a[68:71], v[136:139], v[108:111], a[68:71]
    v_mfma_f32_16x16x32_bf16 a[72:75], v[136:139], v[112:115], a[72:75]
    v_mfma_f32_16x16x32_bf16 a[76:79], v[136:139], v[116:119], a[76:79]
    buffer_load_dwordx4 v[136:139], v3, s[12:15], s42 offen
    buffer_load_dwordx4 v[104:107], v1, s[8:11], s40 offen offset:0
    buffer_load_dwordx4 v[108:111], v1, s[8:11], s40 offen offset:1024
    buffer_load_dwordx4 v[112:115], v1, s[8:11], s40 offen offset:2048
    buffer_load_dwordx4 v[116:119], v1, s[8:11], s40 offen offset:3072
    s_mul_i32 s52, s35, 1
    s_mul_i32 s54, s52, 65537
    s_lshr_b32 s54, s54, 16
    s_mul_i32 s54, s54, 1
    s_sub_u32 s52, s52, s54
    s_add_u32 s56, s55, 9437184
    s_add_u32 s57, s43, 2949120
    s_mul_i32 s54, s52, 524288
    s_add_u32 s40, s56, s54
    s_mul_i32 s54, s52, 163840
    s_add_u32 s42, s57, s54
    s_waitcnt vmcnt(36)
    v_mfma_f32_16x16x32_bf16 a[0:3], v[156:159], v[140:143], a[0:3]
    v_mfma_f32_16x16x32_bf16 a[4:7], v[156:159], v[144:147], a[4:7]
    v_mfma_f32_16x16x32_bf16 a[8:11], v[156:159], v[148:151], a[8:11]
    v_mfma_f32_16x16x32_bf16 a[12:15], v[156:159], v[152:155], a[12:15]
    buffer_load_dwordx4 v[156:159], v2, s[12:15], s42 offen offset:0
    v_mfma_f32_16x16x32_bf16 a[16:19], v[160:163], v[140:143], a[16:19]
    v_mfma_f32_16x16x32_bf16 a[20:23], v[160:163], v[144:147], a[20:23]
    v_mfma_f32_16x16x32_bf16 a[24:27], v[160:163], v[148:151], a[24:27]
    v_mfma_f32_16x16x32_bf16 a[28:31], v[160:163], v[152:155], a[28:31]
    buffer_load_dwordx4 v[160:163], v2, s[12:15], s42 offen offset:1024
    v_mfma_f32_16x16x32_bf16 a[32:35], v[164:167], v[140:143], a[32:35]
    v_mfma_f32_16x16x32_bf16 a[36:39], v[164:167], v[144:147], a[36:39]
    v_mfma_f32_16x16x32_bf16 a[40:43], v[164:167], v[148:151], a[40:43]
    v_mfma_f32_16x16x32_bf16 a[44:47], v[164:167], v[152:155], a[44:47]
    buffer_load_dwordx4 v[164:167], v2, s[12:15], s42 offen offset:2048
    v_mfma_f32_16x16x32_bf16 a[48:51], v[168:171], v[140:143], a[48:51]
    v_mfma_f32_16x16x32_bf16 a[52:55], v[168:171], v[144:147], a[52:55]
    v_mfma_f32_16x16x32_bf16 a[56:59], v[168:171], v[148:151], a[56:59]
    v_mfma_f32_16x16x32_bf16 a[60:63], v[168:171], v[152:155], a[60:63]
    buffer_load_dwordx4 v[168:171], v2, s[12:15], s42 offen offset:3072
    v_mfma_f32_16x16x32_bf16 a[64:67], v[172:175], v[140:143], a[64:67]
    v_mfma_f32_16x16x32_bf16 a[68:71], v[172:175], v[144:147], a[68:71]
    v_mfma_f32_16x16x32_bf16 a[72:75], v[172:175], v[148:151], a[72:75]
    v_mfma_f32_16x16x32_bf16 a[76:79], v[172:175], v[152:155], a[76:79]
    buffer_load_dwordx4 v[172:175], v3, s[12:15], s42 offen
    buffer_load_dwordx4 v[140:143], v1, s[8:11], s40 offen offset:0
    buffer_load_dwordx4 v[144:147], v1, s[8:11], s40 offen offset:1024
    buffer_load_dwordx4 v[148:151], v1, s[8:11], s40 offen offset:2048
    buffer_load_dwordx4 v[152:155], v1, s[8:11], s40 offen offset:3072
    s_add_u32 s52, s52, 1
    s_add_u32 s40, s40, 524288
    s_add_u32 s42, s42, 163840
    s_cmp_eq_u32 s52, 1
    s_cselect_b32 s52, 0, s52
    s_cselect_b32 s40, s56, s40
    s_cselect_b32 s42, s57, s42
    s_waitcnt vmcnt(36)
    v_mfma_f32_16x16x32_bf16 a[0:3], v[192:195], v[176:179], a[0:3]
    v_mfma_f32_16x16x32_bf16 a[4:7], v[192:195], v[180:183], a[4:7]
    v_mfma_f32_16x16x32_bf16 a[8:11], v[192:195], v[184:187], a[8:11]
    v_mfma_f32_16x16x32_bf16 a[12:15], v[192:195], v[188:191], a[12:15]
    v_mfma_f32_16x16x32_bf16 a[16:19], v[196:199], v[176:179], a[16:19]
    v_mfma_f32_16x16x32_bf16 a[20:23], v[196:199], v[180:183], a[20:23]
    v_mfma_f32_16x16x32_bf16 a[24:27], v[196:199], v[184:187], a[24:27]
    v_mfma_f32_16x16x32_bf16 a[28:31], v[196:199], v[188:191], a[28:31]
    v_mfma_f32_16x16x32_bf16 a[32:35], v[200:203], v[176:179], a[32:35]
    v_mfma_f32_16x16x32_bf16 a[36:39], v[200:203], v[180:183], a[36:39]
    v_mfma_f32_16x16x32_bf16 a[40:43], v[200:203], v[184:187], a[40:43]
    v_mfma_f32_16x16x32_bf16 a[44:47], v[200:203], v[188:191], a[44:47]
    v_mfma_f32_16x16x32_bf16 a[48:51], v[204:207], v[176:179], a[48:51]
    v_mfma_f32_16x16x32_bf16 a[52:55], v[204:207], v[180:183], a[52:55]
    v_mfma_f32_16x16x32_bf16 a[56:59], v[204:207], v[184:187], a[56:59]
    v_mfma_f32_16x16x32_bf16 a[60:63], v[204:207], v[188:191], a[60:63]
    v_mfma_f32_16x16x32_bf16 a[64:67], v[208:211], v[176:179], a[64:67]
    v_mfma_f32_16x16x32_bf16 a[68:71], v[208:211], v[180:183], a[68:71]
    v_mfma_f32_16x16x32_bf16 a[72:75], v[208:211], v[184:187], a[72:75]
    v_mfma_f32_16x16x32_bf16 a[76:79], v[208:211], v[188:191], a[76:79]
    s_waitcnt vmcnt(27)
    buffer_load_dwordx2 v[10:11], v8, s[20:23], 0 offen offset:0
    buffer_load_dwordx2 v[12:13], v8, s[20:23], 0 offen offset:32
    buffer_load_dwordx2 v[14:15], v8, s[20:23], 0 offen offset:64
    buffer_load_dwordx2 v[16:17], v8, s[20:23], 0 offen offset:96
    buffer_load_dwordx2 v[18:19], v8, s[20:23], 0 offen offset:128
    v_mfma_f32_16x16x32_bf16 a[0:3], v[48:51], v[32:35], a[0:3]
    v_mfma_f32_16x16x32_bf16 a[4:7], v[48:51], v[36:39], a[4:7]
    v_mfma_f32_16x16x32_bf16 a[8:11], v[48:51], v[40:43], a[8:11]
    v_mfma_f32_16x16x32_bf16 a[12:15], v[48:51], v[44:47], a[12:15]
    v_mfma_f32_16x16x32_bf16 a[16:19], v[52:55], v[32:35], a[16:19]
    v_mfma_f32_16x16x32_bf16 a[20:23], v[52:55], v[36:39], a[20:23]
    v_mfma_f32_16x16x32_bf16 a[24:27], v[52:55], v[40:43], a[24:27]
    v_mfma_f32_16x16x32_bf16 a[28:31], v[52:55], v[44:47], a[28:31]
    v_mfma_f32_16x16x32_bf16 a[32:35], v[56:59], v[32:35], a[32:35]
    v_mfma_f32_16x16x32_bf16 a[36:39], v[56:59], v[36:39], a[36:39]
    v_mfma_f32_16x16x32_bf16 a[40:43], v[56:59], v[40:43], a[40:43]
    v_mfma_f32_16x16x32_bf16 a[44:47], v[56:59], v[44:47], a[44:47]
    v_mfma_f32_16x16x32_bf16 a[48:51], v[60:63], v[32:35], a[48:51]
    v_mfma_f32_16x16x32_bf16 a[52:55], v[60:63], v[36:39], a[52:55]
    v_mfma_f32_16x16x32_bf16 a[56:59], v[60:63], v[40:43], a[56:59]
    v_mfma_f32_16x16x32_bf16 a[60:63], v[60:63], v[44:47], a[60:63]
    v_mfma_f32_16x16x32_bf16 a[64:67], v[64:67], v[32:35], a[64:67]
    v_mfma_f32_16x16x32_bf16 a[68:71], v[64:67], v[36:39], a[68:71]
    v_mfma_f32_16x16x32_bf16 a[72:75], v[64:67], v[40:43], a[72:75]
    v_mfma_f32_16x16x32_bf16 a[76:79], v[64:67], v[44:47], a[76:79]
    s_waitcnt vmcnt(23)
    v_mfma_f32_16x16x32_bf16 a[0:3], v[84:87], v[68:71], a[0:3]
    v_mfma_f32_16x16x32_bf16 a[4:7], v[84:87], v[72:75], a[4:7]
    v_mfma_f32_16x16x32_bf16 a[8:11], v[84:87], v[76:79], a[8:11]
    v_mfma_f32_16x16x32_bf16 a[12:15], v[84:87], v[80:83], a[12:15]
    v_mfma_f32_16x16x32_bf16 a[16:19], v[88:91], v[68:71], a[16:19]
    v_mfma_f32_16x16x32_bf16 a[20:23], v[88:91], v[72:75], a[20:23]
    v_mfma_f32_16x16x32_bf16 a[24:27], v[88:91], v[76:79], a[24:27]
    v_mfma_f32_16x16x32_bf16 a[28:31], v[88:91], v[80:83], a[28:31]
    v_mfma_f32_16x16x32_bf16 a[32:35], v[92:95], v[68:71], a[32:35]
    v_mfma_f32_16x16x32_bf16 a[36:39], v[92:95], v[72:75], a[36:39]
    v_mfma_f32_16x16x32_bf16 a[40:43], v[92:95], v[76:79], a[40:43]
    v_mfma_f32_16x16x32_bf16 a[44:47], v[92:95], v[80:83], a[44:47]
    v_mfma_f32_16x16x32_bf16 a[48:51], v[96:99], v[68:71], a[48:51]
    v_mfma_f32_16x16x32_bf16 a[52:55], v[96:99], v[72:75], a[52:55]
    v_mfma_f32_16x16x32_bf16 a[56:59], v[96:99], v[76:79], a[56:59]
    v_mfma_f32_16x16x32_bf16 a[60:63], v[96:99], v[80:83], a[60:63]
    v_mfma_f32_16x16x32_bf16 a[64:67], v[100:103], v[68:71], a[64:67]
    v_mfma_f32_16x16x32_bf16 a[68:71], v[100:103], v[72:75], a[68:71]
    v_mfma_f32_16x16x32_bf16 a[72:75], v[100:103], v[76:79], a[72:75]
    v_mfma_f32_16x16x32_bf16 a[76:79], v[100:103], v[80:83], a[76:79]
    s_waitcnt vmcnt(14)
    v_mfma_f32_16x16x32_bf16 a[0:3], v[120:123], v[104:107], a[0:3]
    v_mfma_f32_16x16x32_bf16 a[4:7], v[120:123], v[108:111], a[4:7]
    v_mfma_f32_16x16x32_bf16 a[8:11], v[120:123], v[112:115], a[8:11]
    v_mfma_f32_16x16x32_bf16 a[12:15], v[120:123], v[116:119], a[12:15]
    v_mfma_f32_16x16x32_bf16 a[16:19], v[124:127], v[104:107], a[16:19]
    v_mfma_f32_16x16x32_bf16 a[20:23], v[124:127], v[108:111], a[20:23]
    v_mfma_f32_16x16x32_bf16 a[24:27], v[124:127], v[112:115], a[24:27]
    v_mfma_f32_16x16x32_bf16 a[28:31], v[124:127], v[116:119], a[28:31]
    v_mfma_f32_16x16x32_bf16 a[32:35], v[128:131], v[104:107], a[32:35]
    v_mfma_f32_16x16x32_bf16 a[36:39], v[128:131], v[108:111], a[36:39]
    v_mfma_f32_16x16x32_bf16 a[40:43], v[128:131], v[112:115], a[40:43]
    v_mfma_f32_16x16x32_bf16 a[44:47], v[128:131], v[116:119], a[44:47]
    v_mfma_f32_16x16x32_bf16 a[48:51], v[132:135], v[104:107], a[48:51]
    v_mfma_f32_16x16x32_bf16 a[52:55], v[132:135], v[108:111], a[52:55]
    v_mfma_f32_16x16x32_bf16 a[56:59], v[132:135], v[112:115], a[56:59]
    v_mfma_f32_16x16x32_bf16 a[60:63], v[132:135], v[116:119], a[60:63]
    v_mfma_f32_16x16x32_bf16 a[64:67], v[136:139], v[104:107], a[64:67]
    v_mfma_f32_16x16x32_bf16 a[68:71], v[136:139], v[108:111], a[68:71]
    v_mfma_f32_16x16x32_bf16 a[72:75], v[136:139], v[112:115], a[72:75]
    v_mfma_f32_16x16x32_bf16 a[76:79], v[136:139], v[116:119], a[76:79]
    s_waitcnt vmcnt(5)
    v_mfma_f32_16x16x32_bf16 a[0:3], v[156:159], v[140:143], a[0:3]
    v_mfma_f32_16x16x32_bf16 a[4:7], v[156:159], v[144:147], a[4:7]
    v_mfma_f32_16x16x32_bf16 a[8:11], v[156:159], v[148:151], a[8:11]
    v_mfma_f32_16x16x32_bf16 a[12:15], v[156:159], v[152:155], a[12:15]
    v_mfma_f32_16x16x32_bf16 a[16:19], v[160:163], v[140:143], a[16:19]
    v_mfma_f32_16x16x32_bf16 a[20:23], v[160:163], v[144:147], a[20:23]
    v_mfma_f32_16x16x32_bf16 a[24:27], v[160:163], v[148:151], a[24:27]
    v_mfma_f32_16x16x32_bf16 a[28:31], v[160:163], v[152:155], a[28:31]
    v_mfma_f32_16x16x32_bf16 a[32:35], v[164:167], v[140:143], a[32:35]
    ds_write_b128 v9, a[0:3] offset:0
    v_mfma_f32_16x16x32_bf16 a[36:39], v[164:167], v[144:147], a[36:39]
    ds_write_b128 v9, a[4:7] offset:1024
    v_mfma_f32_16x16x32_bf16 a[40:43], v[164:167], v[148:151], a[40:43]
    ds_write_b128 v9, a[8:11] offset:2048
    v_mfma_f32_16x16x32_bf16 a[44:47], v[164:167], v[152:155], a[44:47]
    ds_write_b128 v9, a[12:15] offset:3072
    v_mfma_f32_16x16x32_bf16 a[48:51], v[168:171], v[140:143], a[48:51]
    ds_write_b128 v9, a[16:19] offset:4096
    v_mfma_f32_16x16x32_bf16 a[52:55], v[168:171], v[144:147], a[52:55]
    ds_write_b128 v9, a[20:23] offset:5120
    v_mfma_f32_16x16x32_bf16 a[56:59], v[168:171], v[148:151], a[56:59]
    ds_write_b128 v9, a[24:27] offset:6144
    v_mfma_f32_16x16x32_bf16 a[60:63], v[168:171], v[152:155], a[60:63]
    ds_write_b128 v9, a[28:31] offset:7168
    v_mfma_f32_16x16x32_bf16 a[64:67], v[172:175], v[140:143], a[64:67]
    ds_write_b128 v9, a[32:35] offset:8192
    v_mfma_f32_16x16x32_bf16 a[68:71], v[172:175], v[144:147], a[68:71]
    ds_write_b128 v9, a[36:39] offset:9216
    v_mfma_f32_16x16x32_bf16 a[72:75], v[172:175], v[148:151], a[72:75]
    ds_write_b128 v9, a[40:43] offset:10240
    v_mfma_f32_16x16x32_bf16 a[76:79], v[172:175], v[152:155], a[76:79]
    ds_write_b128 v9, a[44:47] offset:11264
    ds_write_b128 v9, a[48:51] offset:12288
    ds_write_b128 v9, a[52:55] offset:13312
    ds_write_b128 v9, a[56:59] offset:14336
    ds_write_b128 v9, a[60:63] offset:15360
    s_nop 7
    ds_write_b128 v9, a[64:67] offset:16384
    ds_write_b128 v9, a[68:71] offset:17408
    ds_write_b128 v9, a[72:75] offset:18432
    ds_write_b128 v9, a[76:79] offset:19456
    s_waitcnt lgkmcnt(0)
    s_barrier
    ds_read_b128 v[64:67], v20 offset:0
    ds_read_b128 v[68:71], v20 offset:20480
    ds_read_b128 v[72:75], v21 offset:0
    ds_read_b128 v[76:79], v21 offset:20480
    ds_read_b128 v[80:83], v20 offset:4096
    ds_read_b128 v[84:87], v20 offset:24576
    ds_read_b128 v[88:91], v21 offset:4096
    ds_read_b128 v[92:95], v21 offset:24576
    ds_read_b128 v[96:99], v20 offset:8192
    ds_read_b128 v[100:103], v20 offset:28672
    ds_read_b128 v[104:107], v21 offset:8192
    ds_read_b128 v[108:111], v21 offset:28672
    ds_read_b128 v[112:115], v20 offset:12288
    ds_read_b128 v[116:119], v20 offset:32768
    ds_read_b128 v[120:123], v21 offset:12288
    ds_read_b128 v[124:127], v21 offset:32768
    ds_read_b128 v[128:131], v20 offset:16384
    ds_read_b128 v[132:135], v20 offset:36864
    ds_read_b128 v[136:139], v21 offset:16384
    ds_read_b128 v[140:143], v21 offset:36864
    s_waitcnt vmcnt(0)
    s_mov_b32 s47, 0xffff0000
    s_waitcnt lgkmcnt(15)
    v_add_f32 v64, v64, v68
    v_add_f32 v72, v72, v76
    v_add_f32 v65, v65, v69
    v_add_f32 v73, v73, v77
    v_add_f32 v66, v66, v70
    v_add_f32 v74, v74, v78
    v_add_f32 v67, v67, v71
    v_add_f32 v75, v75, v79
    v_lshlrev_b32 v40, 16, v10
    v_and_b32 v41, s47, v10
    v_lshlrev_b32 v42, 16, v11
    v_and_b32 v43, s47, v11
    v_add_f32 v64, v64, v72
    v_add_f32 v65, v65, v73
    v_add_f32 v66, v66, v74
    v_add_f32 v67, v67, v75
    v_add_f32 v64, v64, v40
    v_add_f32 v65, v65, v41
    v_add_f32 v66, v66, v42
    v_add_f32 v67, v67, v43
    v_cvt_pk_bf16_f32 v68, v64, v65
    v_cvt_pk_bf16_f32 v69, v66, v67
    buffer_store_dwordx2 v[68:69], v8, s[24:27], 0 offen offset:0
    s_waitcnt lgkmcnt(12)
    v_add_f32 v80, v80, v84
    v_add_f32 v88, v88, v92
    v_add_f32 v81, v81, v85
    v_add_f32 v89, v89, v93
    v_add_f32 v82, v82, v86
    v_add_f32 v90, v90, v94
    v_add_f32 v83, v83, v87
    v_add_f32 v91, v91, v95
    v_lshlrev_b32 v40, 16, v12
    v_and_b32 v41, s47, v12
    v_lshlrev_b32 v42, 16, v13
    v_and_b32 v43, s47, v13
    v_add_f32 v80, v80, v88
    v_add_f32 v81, v81, v89
    v_add_f32 v82, v82, v90
    v_add_f32 v83, v83, v91
    v_add_f32 v80, v80, v40
    v_add_f32 v81, v81, v41
    v_add_f32 v82, v82, v42
    v_add_f32 v83, v83, v43
    v_cvt_pk_bf16_f32 v84, v80, v81
    v_cvt_pk_bf16_f32 v85, v82, v83
    buffer_store_dwordx2 v[84:85], v8, s[24:27], 0 offen offset:32
    s_waitcnt lgkmcnt(8)
    v_add_f32 v96, v96, v100
    v_add_f32 v104, v104, v108
    v_add_f32 v97, v97, v101
    v_add_f32 v105, v105, v109
    v_add_f32 v98, v98, v102
    v_add_f32 v106, v106, v110
    v_add_f32 v99, v99, v103
    v_add_f32 v107, v107, v111
    v_lshlrev_b32 v40, 16, v14
    v_and_b32 v41, s47, v14
    v_lshlrev_b32 v42, 16, v15
    v_and_b32 v43, s47, v15
    v_add_f32 v96, v96, v104
    v_add_f32 v97, v97, v105
    v_add_f32 v98, v98, v106
    v_add_f32 v99, v99, v107
    v_add_f32 v96, v96, v40
    v_add_f32 v97, v97, v41
    v_add_f32 v98, v98, v42
    v_add_f32 v99, v99, v43
    v_cvt_pk_bf16_f32 v100, v96, v97
    v_cvt_pk_bf16_f32 v101, v98, v99
    buffer_store_dwordx2 v[100:101], v8, s[24:27], 0 offen offset:64
    s_waitcnt lgkmcnt(4)
    v_add_f32 v112, v112, v116
    v_add_f32 v120, v120, v124
    v_add_f32 v113, v113, v117
    v_add_f32 v121, v121, v125
    v_add_f32 v114, v114, v118
    v_add_f32 v122, v122, v126
    v_add_f32 v115, v115, v119
    v_add_f32 v123, v123, v127
    v_lshlrev_b32 v40, 16, v16
    v_and_b32 v41, s47, v16
    v_lshlrev_b32 v42, 16, v17
    v_and_b32 v43, s47, v17
    v_add_f32 v112, v112, v120
    v_add_f32 v113, v113, v121
    v_add_f32 v114, v114, v122
    v_add_f32 v115, v115, v123
    v_add_f32 v112, v112, v40
    v_add_f32 v113, v113, v41
    v_add_f32 v114, v114, v42
    v_add_f32 v115, v115, v43
    v_cvt_pk_bf16_f32 v116, v112, v113
    v_cvt_pk_bf16_f32 v117, v114, v115
    buffer_store_dwordx2 v[116:117], v8, s[24:27], 0 offen offset:96
    s_waitcnt lgkmcnt(0)
    v_add_f32 v128, v128, v132
    v_add_f32 v136, v136, v140
    v_add_f32 v129, v129, v133
    v_add_f32 v137, v137, v141
    v_add_f32 v130, v130, v134
    v_add_f32 v138, v138, v142
    v_add_f32 v131, v131, v135
    v_add_f32 v139, v139, v143
    v_lshlrev_b32 v40, 16, v18
    v_and_b32 v41, s47, v18
    v_lshlrev_b32 v42, 16, v19
    v_and_b32 v43, s47, v19
    v_add_f32 v128, v128, v136
    v_add_f32 v129, v129, v137
    v_add_f32 v130, v130, v138
    v_add_f32 v131, v131, v139
    v_add_f32 v128, v128, v40
    v_add_f32 v129, v129, v41
    v_add_f32 v130, v130, v42
    v_add_f32 v131, v131, v43
    v_cvt_pk_bf16_f32 v132, v128, v129
    v_cvt_pk_bf16_f32 v133, v130, v131
    buffer_store_dwordx2 v[132:133], v8, s[24:27], 0 offen offset:128
K2_end:
    s_endpgm
K_code_end:
.section .rodata,"a"
.p2align 6
.amdhsa_kernel k1_kernel
  .amdhsa_next_free_vgpr 256
  .amdhsa_next_free_sgpr 102
  .amdhsa_accum_offset 256
  .amdhsa_group_segment_fixed_size 0
  .amdhsa_kernarg_size 80
  .amdhsa_user_sgpr_count 2
  .amdhsa_user_sgpr_kernarg_segment_ptr 1
  .amdhsa_system_sgpr_workgroup_id_x 1
.end_amdhsa_kernel
.p2align 6
.amdhsa_kernel k2_kernel
  .amdhsa_next_free_vgpr 336
  .amdhsa_next_free_sgpr 102
  .amdhsa_accum_offset 256
  .amdhsa_group_segment_fixed_size 0
  .amdhsa_kernarg_size 80
  .amdhsa_user_sgpr_count 2
  .amdhsa_user_sgpr_kernarg_segment_ptr 1
  .amdhsa_system_sgpr_workgroup_id_x 1
.end_amdhsa_kernel
```
